```python
import torch

def _softmax(x, axis=-1):
    return torch.softmax(x, dim=axis)

def _gelu(x):
    return torch.nn.functional.gelu(x, approximate='tanh')

def _silu(x):
    return torch.nn.functional.silu(x)

def _sigmoid(x):
    return torch.sigmoid(x)

def _layernorm(x, axis=-1, eps=1e-05):
    m = x.mean(dim=axis, keepdim=True)
    v = x.var(dim=axis, keepdim=True, unbiased=False)
    return (x - m) / torch.sqrt(v + eps)

def _scatter_add(tgt, idx, src, axis=0):
    return tgt.clone().index_add_(axis, idx, src)

def _segment_sum(src, seg, n):
    out = torch.zeros((n,) + src.shape[1:], dtype=src.dtype)
    return out.index_add_(0, seg, src)

def _pad(x, pw):
    flat = tuple((v for pair in reversed(pw) for v in pair))
    return torch.nn.functional.pad(x, flat)
kernel_name = 'gather_scatter__tensor_product_equiv_equiformer__graph'

def setup_inputs():

    _w = lambda a: (lambda t: t.to(torch.bfloat16) if t.is_floating_point() else t)(torch.as_tensor(a))
    N, deg, C, De = (12500, 64, 64, max(0, 1))
    E = N * deg
    src = (lambda lo, hi, *s: torch.randint(lo, hi, s))(0, N, E).to(torch.int64)
    dst = (lambda lo, hi, *s: torch.randint(lo, hi, s))(0, N, E).to(torch.int64)
    rvec = (lambda *s: torch.randn(*s, dtype=torch.bfloat16) * 0.05)(E, 3).to(float)
    rn = (torch.linalg.norm(rvec, dim=-1, keepdim=True) + 1e-06).to(float)
    rhat = (rvec / rn).to(float)
    eps = torch.zeros((3, 3, 3), dtype=float)
    eps[0, 1, 2] = eps[1, 2, 0] = eps[2, 0, 1] = 1.0
    eps[0, 2, 1] = eps[2, 1, 0] = eps[1, 0, 2] = -1.0
    return {'x': _w((lambda *s: torch.randn(*s, dtype=torch.bfloat16) * 0.4)(N, 4 * C).to(float)), 'rhat': _w(rhat), 'e_attr': _w((lambda *s: torch.randn(*s, dtype=torch.bfloat16) * 0.4)(E, De).to(float)), 'src': _w(src), 'dst': _w(dst), 'w_rad': _w((lambda *s: torch.randn(*s, dtype=torch.bfloat16) * 0.4)(De, 5 * C).to(float)), 'w_si0': _w((lambda *s: torch.randn(*s, dtype=torch.bfloat16) * 0.4)(2 * C, C).to(float)), 'w_si1': _w((lambda *s: torch.randn(*s, dtype=torch.bfloat16) * 0.05)(3 * C, C).to(float)), 'cg_eps': _w(eps)}

def reference(x, rhat, e_attr, src, dst, w_rad, w_si0, w_si1, cg_eps):
    N = x.shape[0]
    C = w_si0.shape[1]
    E = rhat.shape[0]
    x0 = x[:, :C].clone()
    x1 = x[:, C:].reshape(N, 3, C)
    R = (e_attr @ w_rad).reshape(E, 5, C)
    f0 = x0[src]
    f1 = x1[src]
    Y1 = rhat
    p00_0 = f0 * R[:, 0, :]
    p11_0 = torch.einsum('ejc,ej->ec', f1, Y1) * R[:, 1, :]
    p01_1 = torch.einsum('ec,ej->ejc', f0, Y1) * R[:, 2, :][:, None, :]
    p10_1 = f1 * R[:, 3, :][:, None, :]
    p11_1 = torch.einsum('ijk,ekc,ej->eic', cg_eps, f1, Y1) * R[:, 4, :][:, None, :]
    m0 = torch.concatenate([p00_0, p11_0], axis=-1) @ w_si0
    m1 = torch.einsum('ejp,pc->ejc', torch.concatenate([p01_1, p10_1, p11_1], axis=-1), w_si1)
    agg0 = _segment_sum(m0, dst, N)
    agg1 = _segment_sum(m1.reshape(E, 3 * C), dst, N).reshape(N, 3, C)
    gate = _sigmoid(agg0)
    out1 = agg1 * gate[:, None, :]
    return torch.concatenate([agg0, out1.reshape(N, 3 * C)], axis=-1)
```

```asm
; @launch grid=(256,1,1) block=(1024,1,1) lds=159296
.amdgcn_target "amdgcn-amd-amdhsa--gfx950"
.text
.globl gather_scatter__tensor_product_equiv_equiformer__graph_kernel
.p2align 8
.type gather_scatter__tensor_product_equiv_equiformer__graph_kernel,@function
gather_scatter__tensor_product_equiv_equiformer__graph_kernel:
    s_load_dwordx16 s[4:19], s[0:1], 0
    s_load_dwordx8 s[20:27], s[0:1], 64
    s_cmp_ge_u32 s2, 256
    s_cbranch_scc1 K2_end
    s_getpc_b64 s[62:63]
P_pc0:
    v_sub_u32 v9, 1023, v0
    v_lshlrev_b32 v9, 7, v9
    v_cmp_gt_u32 vcc, K2_cold-P_pc0, v9
    s_mov_b64 exec, vcc
    s_cbranch_execz P_ncw
    global_load_dword v127, v9, s[62:63]
P_ncw:
    s_mov_b64 exec, -1
    v_cmp_gt_u32 vcc, 768, v0
    v_add_u32 v9, 704, v0
    v_subrev_u32 v10, 64, v0
    v_min_u32 v9, v9, v10
    v_cndmask_b32 v0, v0, v9, vcc
    v_lshrrev_b32 v9, 6, v0
    v_lshlrev_b32 v10, 2, v0
    v_cmp_eq_u32 vcc, 14, v9
    v_readfirstlane_b32 s3, v9
    v_mov_b32 v13, 0
    v_mov_b32 v12, 0x7fff0000
    v_cndmask_b32 v12, v13, v12, vcc
    s_mul_i32 s55, s2, 768
    ds_write2st64_b32 v10, v13, v12 offset0:0 offset1:16
    s_cmp_ge_u32 s3, 12
    s_cbranch_scc1 H_entry
    s_setprio 2
    v_add_u32 v6, s55, v0
    v_lshlrev_b32 v7, 3, v6
    v_lshlrev_b32 v6, 4, v6
    v_add_u32 v8, v6, v7
    s_waitcnt lgkmcnt(0)
    global_load_dwordx4 v[76:79], v6, s[12:13]
    s_barrier
    global_load_dwordx4 v[80:83], v6, s[10:11]
    s_mov_b32 s93, 21400
    s_mov_b32 s94, -49
    s_mov_b32 s95, 671
    s_mov_b32 s96, 0xffff0000
    s_mov_b32 s63, 256
    v_and_b32 v15, 63, v0
    s_mov_b32 s36, s26
    s_mov_b32 s37, s27
    s_mov_b32 s38, 10194944
    s_mov_b32 s39, 0x20000
    v_mov_b32 v16, 4
    v_lshlrev_b32 v17, 4, v15
    s_waitcnt vmcnt(1)
    v_mul_u32_u24 v92, s93, v76
    v_mul_u32_u24 v93, s93, v77
    v_mul_u32_u24 v94, s93, v78
    v_mul_u32_u24 v95, s93, v79
    v_lshrrev_b32 v92, 20, v92
    v_lshrrev_b32 v93, 20, v93
    v_lshrrev_b32 v94, 20, v94
    v_lshrrev_b32 v95, 20, v95
    v_mad_i32_i24 v76, v92, s94, v76
    v_mad_i32_i24 v77, v93, s94, v77
    v_mad_i32_i24 v78, v94, s94, v78
    v_mad_i32_i24 v79, v95, s94, v79
    v_lshlrev_b32 v92, 2, v92
    v_lshlrev_b32 v93, 2, v93
    v_lshlrev_b32 v94, 2, v94
    v_lshlrev_b32 v95, 2, v95
    ds_add_rtn_u32 v96, v92, v16 offset:2048
    ds_add_rtn_u32 v97, v93, v16 offset:2048
    ds_add_rtn_u32 v98, v94, v16 offset:2048
    ds_add_rtn_u32 v99, v95, v16 offset:2048
    global_load_dwordx2 v[84:85], v7, s[8:9]
    global_load_dwordx4 v[86:89], v8, s[6:7]
    global_load_dwordx2 v[90:91], v8, s[6:7] offset:16
P_e1:
    s_waitcnt lgkmcnt(0)
    s_barrier
    ds_read_b128 v[112:115], v17 offset:2048
    ds_read_b32 v122, v13 offset:7208
    s_waitcnt vmcnt(3)
    v_mul_u32_u24 v100, s95, v80
    v_mul_u32_u24 v101, s95, v81
    v_mul_u32_u24 v102, s95, v82
    v_mul_u32_u24 v103, s95, v83
    v_lshrrev_b32 v100, 20, v100
    v_lshrrev_b32 v101, 20, v101
    v_lshrrev_b32 v102, 20, v102
    v_lshrrev_b32 v103, 20, v103
    s_waitcnt lgkmcnt(0)
    v_add3_u32 v116, v112, v113, v114
    v_add_u32 v116, v116, v115
    v_mov_b32 v117, v116
    v_lshl_or_b32 v100, v76, 3, v100
    v_lshl_or_b32 v101, v77, 3, v101
    v_add_u32_dpp v117, v117, v117 row_shr:1 row_mask:0xf bank_mask:0xf bound_ctrl:0
    v_lshl_or_b32 v102, v78, 3, v102
    v_lshl_or_b32 v103, v79, 3, v103
    v_add_u32_dpp v117, v117, v117 row_shr:2 row_mask:0xf bank_mask:0xf bound_ctrl:0
    v_lshl_or_b32 v100, v80, 14, v100
    v_lshl_or_b32 v101, v81, 14, v101
    v_add_u32_dpp v117, v117, v117 row_shr:4 row_mask:0xf bank_mask:0xf bound_ctrl:0
    v_lshl_or_b32 v102, v82, 14, v102
    v_lshl_or_b32 v103, v83, 14, v103
    v_add_u32_dpp v117, v117, v117 row_shr:8 row_mask:0xf bank_mask:0xf bound_ctrl:0
    v_lshl_add_u32 v100, v100, 2, s63
    v_lshl_add_u32 v101, v101, 2, s63
    v_add_u32_dpp v117, v117, v117 row_bcast:15 row_mask:0xa bank_mask:0xf
    v_lshl_add_u32 v102, v102, 2, s63
    v_lshl_add_u32 v103, v103, 2, s63
    v_add_u32_dpp v117, v117, v117 row_bcast:31 row_mask:0xc bank_mask:0xf
    v_sub_u32 v118, v117, v116
    v_add_u32 v119, v118, v112
    v_add_u32 v120, v119, v113
    v_add_u32 v121, v120, v114
    ds_write_b128 v17, v[118:121] offset:3072
    ds_read_b32 v92, v92 offset:3072
    ds_read_b32 v93, v93 offset:3072
    ds_read_b32 v94, v94 offset:3072
    ds_read_b32 v95, v95 offset:3072
    s_waitcnt lgkmcnt(3)
    v_add_u32 v92, v92, v96
    s_waitcnt lgkmcnt(2)
    v_add_u32 v93, v93, v97
    s_waitcnt lgkmcnt(1)
    v_add_u32 v94, v94, v98
    s_waitcnt lgkmcnt(0)
    v_add_u32 v95, v95, v99
    ds_write_b32 v92, v100 offset:50176
    ds_write_b32 v93, v101 offset:50176
    ds_write_b32 v94, v102 offset:50176
    ds_write_b32 v95, v103 offset:50176
    s_mov_b64 exec, 1
    ds_add_u32 v13, v16 offset:7204
    s_mov_b64 exec, -1
    v_lshlrev_b32 v96, 1, v92
    v_lshlrev_b32 v97, 1, v93
    v_lshlrev_b32 v98, 1, v94
    v_lshlrev_b32 v99, 1, v95
    s_waitcnt vmcnt(0)
    v_lshlrev_b32 v9, 16, v84
    v_lshlrev_b32 v10, 16, v86
    v_and_b32 v11, s96, v86
    v_lshlrev_b32 v12, 16, v87
    v_mul_f32 v10, v9, v10
    v_mul_f32 v11, v9, v11
    v_mul_f32 v12, v9, v12
    v_cvt_pk_bf16_f32 v104, v9, v10
    v_cvt_pk_bf16_f32 v105, v11, v12
    ds_write_b64 v96, v[104:105] offset:62720
    v_and_b32 v9, s96, v84
    v_and_b32 v10, s96, v87
    v_lshlrev_b32 v11, 16, v88
    v_and_b32 v12, s96, v88
    v_mul_f32 v10, v9, v10
    v_mul_f32 v11, v9, v11
    v_mul_f32 v12, v9, v12
    v_cvt_pk_bf16_f32 v106, v9, v10
    v_cvt_pk_bf16_f32 v107, v11, v12
    ds_write_b64 v97, v[106:107] offset:62720
    v_lshlrev_b32 v9, 16, v85
    v_lshlrev_b32 v10, 16, v89
    v_and_b32 v11, s96, v89
    v_lshlrev_b32 v12, 16, v90
    v_mul_f32 v10, v9, v10
    v_mul_f32 v11, v9, v11
    v_mul_f32 v12, v9, v12
    v_cvt_pk_bf16_f32 v108, v9, v10
    v_cvt_pk_bf16_f32 v109, v11, v12
    ds_write_b64 v98, v[108:109] offset:62720
    v_and_b32 v9, s96, v85
    v_and_b32 v10, s96, v90
    v_lshlrev_b32 v11, 16, v91
    v_and_b32 v12, s96, v91
    v_mul_f32 v10, v9, v10
    v_mul_f32 v11, v9, v11
    v_mul_f32 v12, v9, v12
    v_cvt_pk_bf16_f32 v110, v9, v10
    v_cvt_pk_bf16_f32 v111, v11, v12
    ds_write_b64 v99, v[110:111] offset:62720
    s_mov_b64 exec, 1
    ds_add_u32 v13, v16 offset:7176
    s_mov_b64 exec, -1
    v_readfirstlane_b32 s89, v122
    s_add_u32 s89, s89, 2654435769
    s_mov_b32 s28, s4
    s_mov_b32 s29, s5
    s_mov_b32 s30, 6400000
    s_mov_b32 s31, 0x20000
    s_mov_b32 s32, s22
    s_mov_b32 s33, s23
    s_mov_b32 s34, 6400000
    s_mov_b32 s35, 0x20000
    s_and_b32 s88, s2, 7
    s_lshl_b32 s88, s88, 5
    s_lshr_b32 s55, s2, 3
    s_add_u32 s88, s88, s55
    s_mov_b32 s49, 0
    s_mov_b32 s50, 32
    s_mov_b32 s90, 0
    v_mov_b32 v7, 0
    v_lshlrev_b32 v16, 5, v15
    s_lshl_b32 s92, s88, 2
    s_and_b32 s92, s92, 0x3f0
    s_bfe_u32 s55, s88, 0x10001
    s_lshl_b32 s55, s55, 10
    s_add_u32 s92, s92, s55
    s_and_b32 s55, s88, 1
    s_lshl_b32 s55, s55, 3
    s_add_u32 s92, s92, s55
    s_add_u32 s92, s92, 4096
    s_and_b32 s62, s2, 15
    s_lshl_b32 s62, s62, 11
    s_add_u32 s62, s62, 528384
    s_mov_b32 s100, 561152
    s_mov_b32 s101, 3772416
    v_and_b32 v1, 15, v0
    v_lshrrev_b32 v9, 4, v0
    v_mad_u32_u24 v122, v9, 6, v1
    v_cmp_gt_u32 s[60:61], 6, v1
    v_cmp_gt_u32 vcc, 0x100, v122
    v_lshlrev_b32 v1, 4, v1
    v_and_b32 v2, 3, v9
    v_lshlrev_b32 v2, 2, v2
    s_and_b64 s[60:61], s[60:61], vcc
    v_and_b32 v10, 3, v0
    v_mul_u32_u24 v10, 0x202, v10
    v_add_u32 v10, 0x100, v10
    v_or_b32 v11, 0x0c0c0000, v10
    v_lshlrev_b32 v10, 16, v10
    v_or_b32 v10, 0x0c0c, v10
    v_and_b32 v12, 4, v0
    v_cmp_eq_u32 vcc, 0, v12
    v_and_b32 v12, 8, v0
    v_mov_b32 v9, 0x0c0c0c0c
    v_cndmask_b32 v10, v10, v11, vcc
    v_cmp_eq_u32 vcc, 0, v12
    s_mov_b32 s59, 512
    s_mov_b32 s44, 0x01010101
    v_cndmask_b32 v3, v9, v10, vcc
    v_cndmask_b32 v4, v10, v9, vcc
    s_mov_b32 s45, s44
    s_cmp_eq_u32 s3, 11
    s_cselect_b32 s87, 31, 15
    s_mul_i32 s83, s87, s44
    v_mov_b64 v[18:19], 0
    v_mov_b64 v[20:21], 0
    v_mov_b64 v[22:23], 0
    v_mov_b64 v[24:25], 0
    v_mov_b64 v[26:27], 0
    v_mov_b64 v[28:29], 0
    v_mov_b64 v[30:31], 0
    v_mov_b64 v[32:33], 0
    v_mov_b64 v[34:35], 0
    v_mov_b64 v[36:37], 0
    v_mov_b64 v[38:39], 0
    v_mov_b64 v[40:41], 0
    v_mov_b64 v[42:43], 0
    v_mov_b64 v[44:45], 0
    v_mov_b64 v[46:47], 0
    v_mov_b64 v[48:49], 0
    v_mov_b64 v[50:51], 0
    v_mov_b64 v[52:53], 0
    v_mov_b64 v[54:55], 0
    v_mov_b64 v[56:57], 0
    v_mov_b64 v[58:59], 0
    v_mov_b64 v[60:61], 0
    v_mov_b64 v[62:63], 0
    v_mov_b64 v[64:65], 0
    v_mov_b64 v[66:67], 0
    v_mov_b64 v[68:69], 0
    v_mov_b64 v[70:71], 0
    v_mov_b64 v[72:73], 0
    v_mov_b64 v[74:75], 0
    v_mov_b64 v[76:77], 0
    v_mov_b64 v[78:79], 0
    v_mov_b64 v[80:81], 0
    v_mov_b64 v[82:83], 0
    v_mov_b64 v[84:85], 0
    v_mov_b64 v[86:87], 0
    v_mov_b64 v[88:89], 0
    v_mov_b64 v[90:91], 0
    v_mov_b64 v[92:93], 0
    v_mov_b64 v[94:95], 0
    v_mov_b64 v[96:97], 0
    s_mov_b32 s82, 0
    s_mov_b32 s91, 2000
    v_mov_b32 v123, 0
    v_lshlrev_b32 v12, 11, v122
    v_lshlrev_b32 v124, 3, v122
    s_mov_b32 s55, 12544
    v_mul_u32_u24 v122, s55, v122
    v_and_b32 v8, 15, v0
    v_add_u32 v9, 17, v8
    v_lshlrev_b32 v10, 2, v8
    v_mov_b32 v13, 4
    v_lshlrev_b32 v14, 2, v15
    v_add_u32 v8, 1, v8
    s_mov_b32 s5, 16
    s_mov_b32 s97, 0xff
    s_cbranch_scc1 P_w11
P_wp:
    s_sleep 1
    ds_read_b32 v11, v7 offset:7212
    s_waitcnt lgkmcnt(0)
    v_readfirstlane_b32 s55, v11
    s_cmp_lt_u32 s55, 1
    s_cbranch_scc1 P_wp
    s_mov_b32 s91, 2000
    s_mov_b32 s55, 32
    s_mov_b64 exec, s[60:61]
P_poll:
    buffer_load_dwordx2 v[126:127], v12, s[36:39], s92 offen sc1
    s_sub_u32 s91, s91, 1
    s_cbranch_scc1 P_tmo
    s_waitcnt vmcnt(0)
    v_xor_b32 v11, s89, v127
    v_xor_b32 v17, s89, v126
    v_and_or_b32 v11, v17, s97, v11
    v_cmp_ne_u32 vcc, 0, v11
    s_and_b64 exec, exec, vcc
    s_cbranch_scc1 P_poll
    s_mov_b64 exec, s[60:61]
    v_bfe_u32 v123, v126, 8, 12
    v_lshrrev_b32 v11, 20, v126
    v_lshl_add_u32 v122, v11, 2, v122
P_go:
    s_mov_b64 exec, -1
K2_ld:
    v_cmp_lt_u32 vcc, s5, v123
    v_cmp_lt_u32 s[46:47], s55, v123
    s_bcnt1_i32_b64 s4, vcc
    v_mbcnt_lo_u32_b32 v11, vcc_lo, 0
    v_mbcnt_hi_u32_b32 v11, vcc_hi, v11
    v_and_b32 v12, 3, v11
    v_mad_u32_u24 v11, v12, 63, v11
    v_cndmask_b32 v11, 60, v11, vcc
    ds_permute_b32 v16, v11, v122
    ds_permute_b32 v17, v11, v123
    v_sub_u32_dpp v110, v123, v8 row_newbcast:0 row_mask:0xf bank_mask:0xf
    v_add_u32_dpp v98, v122, v10 row_newbcast:0 row_mask:0xf bank_mask:0xf
    v_and_or_b32 v98, v110, 2.0, v98
    buffer_load_dword v110, v98, s[36:39], s100 offen sc1
    v_sub_u32_dpp v111, v123, v8 row_newbcast:1 row_mask:0xf bank_mask:0xf
    v_add_u32_dpp v100, v122, v10 row_newbcast:1 row_mask:0xf bank_mask:0xf
    v_and_or_b32 v100, v111, 2.0, v100
    buffer_load_dword v111, v100, s[36:39], s100 offen sc1
    v_sub_u32_dpp v112, v123, v8 row_newbcast:2 row_mask:0xf bank_mask:0xf
    v_add_u32_dpp v102, v122, v10 row_newbcast:2 row_mask:0xf bank_mask:0xf
    v_and_or_b32 v102, v112, 2.0, v102
    buffer_load_dword v112, v102, s[36:39], s100 offen sc1
    v_sub_u32_dpp v113, v123, v8 row_newbcast:3 row_mask:0xf bank_mask:0xf
    v_add_u32_dpp v104, v122, v10 row_newbcast:3 row_mask:0xf bank_mask:0xf
    v_and_or_b32 v104, v113, 2.0, v104
    buffer_load_dword v113, v104, s[36:39], s100 offen sc1
    v_sub_u32_dpp v114, v123, v8 row_newbcast:4 row_mask:0xf bank_mask:0xf
    v_add_u32_dpp v106, v122, v10 row_newbcast:4 row_mask:0xf bank_mask:0xf
    v_and_or_b32 v106, v114, 2.0, v106
    buffer_load_dword v114, v106, s[36:39], s100 offen sc1
    v_sub_u32_dpp v115, v123, v8 row_newbcast:5 row_mask:0xf bank_mask:0xf
    v_add_u32_dpp v108, v122, v10 row_newbcast:5 row_mask:0xf bank_mask:0xf
    v_and_or_b32 v108, v115, 2.0, v108
    buffer_load_dword v115, v108, s[36:39], s100 offen sc1
    s_cmp_lg_u64 s[46:47], 0
    s_cselect_b32 s55, 8, 0
    s_cmp_gt_u32 s4, 12
    s_cselect_b32 s55, 2, s55
    s_mov_b32 s91, 100000
    s_waitcnt lgkmcnt(0)
    v_sub_u32_dpp v88, v17, v9 row_newbcast:0 row_mask:0xf bank_mask:0xf
    v_add_u32_dpp v82, v16, v10 row_newbcast:0 row_mask:0xf bank_mask:0xf
    v_and_or_b32 v82, v88, 2.0, v82
    buffer_load_dword v88, v82, s[36:39], s100 offen offset:64 sc1
    s_cmp_lt_u32 s4, 5
    s_cbranch_scc1 K2_s1
    v_sub_u32_dpp v89, v17, v9 row_newbcast:1 row_mask:0xf bank_mask:0xf
    v_add_u32_dpp v84, v16, v10 row_newbcast:1 row_mask:0xf bank_mask:0xf
    v_and_or_b32 v84, v89, 2.0, v84
    buffer_load_dword v89, v84, s[36:39], s100 offen offset:64 sc1
    v_sub_u32_dpp v90, v17, v9 row_newbcast:2 row_mask:0xf bank_mask:0xf
    v_add_u32_dpp v86, v16, v10 row_newbcast:2 row_mask:0xf bank_mask:0xf
    v_and_or_b32 v86, v90, 2.0, v86
    buffer_load_dword v90, v86, s[36:39], s100 offen offset:64 sc1
K2_s1:
    v_lshlrev_b32 v98, 1, v98
    v_lshlrev_b32 v100, 1, v100
    v_lshlrev_b32 v102, 1, v102
    v_lshlrev_b32 v104, 1, v104
    v_lshlrev_b32 v106, 1, v106
    v_lshlrev_b32 v108, 1, v108
    v_lshlrev_b32 v82, 1, v82
    v_lshlrev_b32 v84, 1, v84
    v_lshlrev_b32 v86, 1, v86
    s_waitcnt vmcnt(0)
    s_mov_b64 exec, s[60:61]
    buffer_load_dwordx2 v[126:127], v124, s[36:39], s62 offen sc1
    s_mov_b64 exec, -1
K2_flag:
    v_max_u16 v5, v110, v14
    ds_add_rtn_u32 v116, v5, v13 offset:0
    v_max_u16 v6, v111, v14
    ds_add_rtn_u32 v117, v6, v13 offset:0
    v_max_u16 v8, v112, v14
    ds_add_rtn_u32 v118, v8, v13 offset:0
    v_max_u16 v9, v113, v14
    ds_add_rtn_u32 v119, v9, v13 offset:0
    v_max_u16 v10, v114, v14
    ds_add_rtn_u32 v120, v10, v13 offset:0
    v_max_u16 v11, v115, v14
    ds_add_rtn_u32 v121, v11, v13 offset:0
    v_max_u16 v12, v88, v14
    ds_add_rtn_u32 v91, v12, v13 offset:0
    s_cmp_lt_u32 s4, 5
    s_cbranch_scc1 K2_s2
    v_max_u16 v94, v89, v14
    ds_add_rtn_u32 v92, v94, v13 offset:0
    v_max_u16 v95, v90, v14
    ds_add_rtn_u32 v93, v95, v13 offset:0
K2_s2:
    v_mov_b32 v16, s55
    s_mov_b64 exec, 1
    ds_or_b32 v7, v16 offset:7168
    ds_add_u32 v7, v13 offset:7172
    s_mov_b64 exec, -1
    s_cmp_lg_u32 s90, 0
    s_cbranch_scc1 K2_nb
    s_mov_b64 exec, s[60:61]
    s_branch K2_fp1
K2_fp0:
    buffer_load_dwordx2 v[126:127], v124, s[36:39], s62 offen sc1
K2_fp1:
    s_sub_u32 s91, s91, 1
    s_cbranch_scc1 K2_fp2
    s_waitcnt vmcnt(0)
    v_xor_b32 v126, s89, v126
    v_xor_b32 v127, s89, v127
    v_or_b32 v126, v126, v127
    v_cmp_ne_u32 vcc, 0, v126
    s_and_b64 exec, exec, vcc
    s_cbranch_scc1 K2_fp0
K2_fp2:
    s_mov_b64 exec, -1
    s_cmp_lt_u32 s4, 5
    s_cbranch_scc1 K2_s5
    buffer_load_dwordx2 v[84:85], v84, s[36:39], s101 offen offset:128 sc1
    buffer_load_dwordx2 v[86:87], v86, s[36:39], s101 offen offset:128 sc1
K2_s5:
    buffer_load_dwordx2 v[98:99], v98, s[36:39], s101 offen sc1
    buffer_load_dwordx2 v[100:101], v100, s[36:39], s101 offen sc1
    buffer_load_dwordx2 v[102:103], v102, s[36:39], s101 offen sc1
    buffer_load_dwordx2 v[104:105], v104, s[36:39], s101 offen sc1
    buffer_load_dwordx2 v[106:107], v106, s[36:39], s101 offen sc1
    buffer_load_dwordx2 v[108:109], v108, s[36:39], s101 offen sc1
    buffer_load_dwordx2 v[82:83], v82, s[36:39], s101 offen offset:128 sc1
K2_nb:
    v_mul_u32_u24 v15, 10, v0
    v_add_u32_sdwa v110, v15, 0 dst_sel:WORD_0 dst_unused:UNUSED_PRESERVE src0_sel:DWORD src1_sel:DWORD
    v_add_u32_sdwa v111, v15, 1 dst_sel:WORD_0 dst_unused:UNUSED_PRESERVE src0_sel:DWORD src1_sel:DWORD
    v_add_u32_sdwa v112, v15, 2 dst_sel:WORD_0 dst_unused:UNUSED_PRESERVE src0_sel:DWORD src1_sel:DWORD
    v_add_u32_sdwa v113, v15, 3 dst_sel:WORD_0 dst_unused:UNUSED_PRESERVE src0_sel:DWORD src1_sel:DWORD
    v_add_u32_sdwa v114, v15, 4 dst_sel:WORD_0 dst_unused:UNUSED_PRESERVE src0_sel:DWORD src1_sel:DWORD
    v_add_u32_sdwa v115, v15, 5 dst_sel:WORD_0 dst_unused:UNUSED_PRESERVE src0_sel:DWORD src1_sel:DWORD
    v_add_u32_sdwa v88, v15, 6 dst_sel:WORD_0 dst_unused:UNUSED_PRESERVE src0_sel:DWORD src1_sel:DWORD
    v_add_u32_sdwa v89, v15, 8 dst_sel:WORD_0 dst_unused:UNUSED_PRESERVE src0_sel:DWORD src1_sel:DWORD
    v_add_u32_sdwa v90, v15, 9 dst_sel:WORD_0 dst_unused:UNUSED_PRESERVE src0_sel:DWORD src1_sel:DWORD
K2_lk:
    ds_read_b32 v7, v2 offset:7168
    ds_read_b32 v14, v5 offset:2048
    ds_read_b32 v15, v6 offset:2048
    ds_read_b32 v16, v8 offset:2048
    ds_read_b32 v17, v9 offset:2048
    ds_read_b32 v96, v10 offset:2048
    ds_read_b32 v97, v11 offset:2048
    ds_read_b32 v13, v12 offset:2048
    s_waitcnt lgkmcnt(7)
    v_readfirstlane_b32 s51, v7
    s_bitcmp0_b32 s51, 4
    s_cbranch_scc1 K2_lw
    s_and_b32 s55, s51, 3
    s_cbranch_scc1 K2_bad
    s_waitcnt lgkmcnt(6)
    v_add_u32 v116, v14, v116
    ds_write_b32 v116, v110
    s_waitcnt lgkmcnt(6)
    v_add_u32 v117, v15, v117
    ds_write_b32 v117, v111
    s_waitcnt lgkmcnt(6)
    v_add_u32 v118, v16, v118
    ds_write_b32 v118, v112
    s_waitcnt lgkmcnt(6)
    v_add_u32 v119, v17, v119
    ds_write_b32 v119, v113
    s_waitcnt lgkmcnt(6)
    v_add_u32 v120, v96, v120
    ds_write_b32 v120, v114
    s_waitcnt lgkmcnt(6)
    v_add_u32 v121, v97, v121
    ds_write_b32 v121, v115
    s_waitcnt lgkmcnt(6)
    v_add_u32 v91, v13, v91
    ds_write_b32 v91, v88
    v_mul_u32_u24 v16, 0x50, v0
    v_add_u32 v16, 102912, v16
    s_cmp_lt_u32 s4, 5
    s_cbranch_scc1 K2_s4
    ds_read_b32 v94, v94 offset:2048
    ds_read_b32 v95, v95 offset:2048
    s_waitcnt lgkmcnt(0)
    v_add_u32 v92, v94, v92
    ds_write_b32 v92, v89
    v_add_u32 v93, v95, v93
    ds_write_b32 v93, v90
    s_waitcnt vmcnt(7)
    ds_write_b128 v16, v[84:87] offset:64
K2_s4:
    v_lshlrev_b32 v7, 2, v0
    s_mul_i32 s55, s3, 1568
    s_add_u32 s55, s55, 7936
    s_mov_b32 s97, 102912
    v_add3_u32 v9, v2, v1, s55
    v_mov_b32 v14, 1
    s_mov_b32 s53, 0
    s_mov_b32 s54, 1
    s_mov_b32 s52, 1
    s_and_b32 s51, s51, 8
    s_cselect_b32 s48, 0, 8
    s_mov_b32 s84, 7
    s_mov_b32 s85, 7
    s_mov_b32 s81, 32
    s_or_b32 s55, s90, s2
    s_lshl4_add_u32 s55, s55, s3
    s_cmp_lg_u32 s55, 10
    s_waitcnt vmcnt(5)
    ds_write_b128 v16, v[98:101] offset:0
    s_waitcnt vmcnt(3)
    ds_write_b128 v16, v[102:105] offset:16
    s_waitcnt vmcnt(1)
    ds_write_b128 v16, v[106:109] offset:32
    s_waitcnt vmcnt(0)
    ds_write_b64 v16, v[82:83] offset:48
    s_cbranch_scc0 K2_ep
K2_join:
    s_setprio 3
    s_waitcnt lgkmcnt(0)
    s_barrier
    ds_read_b32 v6, v7 offset:4096
    s_waitcnt lgkmcnt(0)
    v_cmp_ne_u32 s[56:57], 0, v6
    s_and_b32 s56, s56, s83
    s_and_b32 s57, s57, s83
    s_branch K2_ns_1
K2_lw:
    s_setprio 0
K2_lw1:
    s_sleep 1
    ds_read_b32 v7, v2 offset:7168
    s_waitcnt lgkmcnt(0)
    v_readfirstlane_b32 s51, v7
    s_bitcmp0_b32 s51, 4
    s_cbranch_scc1 K2_lw1
    s_setprio 2
    s_branch K2_lk
K2_M0:
    s_cmp_eq_u32 s52, 0
    s_waitcnt lgkmcnt(0)
    s_cbranch_scc1 K2_T0
    v_mad_u32_u16 v8, v12, s59, v1 op_sel:[1,0,0,0]
    s_mov_b32 s85, s80
    buffer_load_dwordx4 v[110:113], v8, s[28:31], 0 offen
    buffer_load_dwordx4 v[114:117], v8, s[28:31], 0 offen offset:256
    v_mad_u32_u16 v13, v12, 8, s97
    v_perm_b32 v98, v11, v10, v3
    v_perm_b32 v99, v11, v10, v4
    ds_read_b64 v[10:11], v13
    s_sub_u32 s53, s53, 1
    s_cbranch_scc1 K2_nr_0
    v_add_u32 v7, 16, v7
K2_bk_0:
    ds_read_b32 v12, v7
K2_D0:
    s_cmp_lt_u32 s84, 2
    s_cbranch_scc1 K2_C0_01
    s_cmp_lg_u32 s84, 3
    s_cbranch_scc1 K2_C0_2
    s_waitcnt vmcnt(3)
    v_mfma_f32_16x16x16_bf16 v[66:69], v[98:99], v[102:103], v[66:69]
    v_mfma_f32_16x16x16_bf16 v[70:73], v[98:99], v[104:105], v[70:73]
    s_waitcnt vmcnt(2)
    v_mfma_f32_16x16x16_bf16 v[74:77], v[98:99], v[106:107], v[74:77]
    v_mfma_f32_16x16x16_bf16 v[78:81], v[98:99], v[108:109], v[78:81]
K2_M1:
    s_cmp_eq_u32 s52, 0
    s_waitcnt lgkmcnt(0)
    s_cbranch_scc1 K2_T1
    v_mad_u32_u16 v8, v12, s59, v1 op_sel:[1,0,0,0]
    s_mov_b32 s84, s80
    buffer_load_dwordx4 v[102:105], v8, s[28:31], 0 offen
    buffer_load_dwordx4 v[106:109], v8, s[28:31], 0 offen offset:256
    v_mad_u32_u16 v13, v12, 8, s97
    v_perm_b32 v100, v11, v10, v3
    v_perm_b32 v101, v11, v10, v4
    ds_read_b64 v[10:11], v13
    s_sub_u32 s53, s53, 1
    s_cbranch_scc1 K2_nr_1
    v_add_u32 v7, 16, v7
K2_bk_1:
    ds_read_b32 v12, v7
K2_D1:
    s_cmp_lt_u32 s85, 2
    s_cbranch_scc1 K2_C1_01
    s_cmp_lg_u32 s85, 3
    s_cbranch_scc1 K2_C1_2
    s_waitcnt vmcnt(3)
    v_mfma_f32_16x16x16_bf16 v[66:69], v[100:101], v[110:111], v[66:69]
    v_mfma_f32_16x16x16_bf16 v[70:73], v[100:101], v[112:113], v[70:73]
    s_waitcnt vmcnt(2)
    v_mfma_f32_16x16x16_bf16 v[74:77], v[100:101], v[114:115], v[74:77]
    v_mfma_f32_16x16x16_bf16 v[78:81], v[100:101], v[116:117], v[78:81]
    s_branch K2_M0
K2_nr_0:
    s_lshl_b64 s[46:47], s[44:45], s80
    s_and_b64 s[46:47], s[46:47], s[56:57]
    s_cselect_b32 s55, 0, s48
    s_or_b32 s85, s85, s55
K2_ns_0:
    s_ff1_i32_b64 s58, s[56:57]
    s_cmp_lt_i32 s58, 0
    s_cbranch_scc1 K2_fin_0
    v_readlane_b32 s55, v6, s58
    s_bitset0_b64 s[56:57], s58
    s_and_b32 s80, s58, 7
    s_lshr_b32 s53, s55, 18
    s_and_b32 s55, s55, 0x3ffff
    v_add_u32 v7, s55, v2
    s_cmp_lt_u32 s58, s81
    s_cbranch_scc1 K2_bk_0
    s_setprio 2
    s_mov_b32 s81, 48
    s_cmp_lt_u32 s58, s81
    s_cbranch_scc1 K2_bk_0
    s_setprio 1
    s_mov_b32 s81, 56
    s_cmp_lt_u32 s58, s81
    s_cbranch_scc1 K2_bk_0
    s_setprio 0
    s_mov_b32 s81, 64
    s_branch K2_bk_0
K2_fin_0:
    s_mov_b32 s52, 0
    s_branch K2_D0
K2_C0_01:
    s_cmp_eq_u32 s84, 0
    s_cbranch_scc1 K2_C0_0
    s_waitcnt vmcnt(3)
    v_mfma_f32_16x16x16_bf16 v[34:37], v[98:99], v[102:103], v[34:37]
    v_mfma_f32_16x16x16_bf16 v[38:41], v[98:99], v[104:105], v[38:41]
    s_waitcnt vmcnt(2)
    v_mfma_f32_16x16x16_bf16 v[42:45], v[98:99], v[106:107], v[42:45]
    v_mfma_f32_16x16x16_bf16 v[46:49], v[98:99], v[108:109], v[46:49]
    s_branch K2_M1
K2_C0_0:
    s_waitcnt vmcnt(3)
    v_mfma_f32_16x16x16_bf16 v[18:21], v[98:99], v[102:103], v[18:21]
    v_mfma_f32_16x16x16_bf16 v[22:25], v[98:99], v[104:105], v[22:25]
    s_waitcnt vmcnt(2)
    v_mfma_f32_16x16x16_bf16 v[26:29], v[98:99], v[106:107], v[26:29]
    v_mfma_f32_16x16x16_bf16 v[30:33], v[98:99], v[108:109], v[30:33]
    s_branch K2_M1
K2_C0_2:
    s_cmp_lg_u32 s84, 2
    s_cbranch_scc1 K2_C0_4
    s_waitcnt vmcnt(3)
    v_mfma_f32_16x16x16_bf16 v[50:53], v[98:99], v[102:103], v[50:53]
    v_mfma_f32_16x16x16_bf16 v[54:57], v[98:99], v[104:105], v[54:57]
    s_waitcnt vmcnt(2)
    v_mfma_f32_16x16x16_bf16 v[58:61], v[98:99], v[106:107], v[58:61]
    v_mfma_f32_16x16x16_bf16 v[62:65], v[98:99], v[108:109], v[62:65]
    s_branch K2_M1
K2_C0_4:
    s_cmp_lg_u32 s84, 4
    s_cbranch_scc1 K2_C0_8
    s_waitcnt vmcnt(3)
    v_mfma_f32_16x16x16_bf16 v[82:85], v[98:99], v[102:103], v[82:85]
    v_mfma_f32_16x16x16_bf16 v[86:89], v[98:99], v[104:105], v[86:89]
    s_waitcnt vmcnt(2)
    v_mfma_f32_16x16x16_bf16 v[90:93], v[98:99], v[106:107], v[90:93]
    v_mfma_f32_16x16x16_bf16 v[94:97], v[98:99], v[108:109], v[94:97]
    s_branch K2_M1
K2_T0:
    s_sub_u32 s54, s54, 1
    s_cbranch_scc1 K2_done
    v_perm_b32 v98, v11, v10, v3
    v_perm_b32 v99, v11, v10, v4
    s_waitcnt vmcnt(0)
    s_branch K2_D0
K2_C0_8:
    s_cmp_lt_u32 s84, 8
    s_cbranch_scc1 K2_M1
    s_mov_b32 s86, 1
    s_cmp_lg_u32 s84, 8
    s_cbranch_scc1 K2_L0_1
    s_waitcnt vmcnt(3)
    v_mfma_f32_16x16x16_bf16 v[18:21], v[98:99], v[102:103], v[18:21]
    v_mfma_f32_16x16x16_bf16 v[22:25], v[98:99], v[104:105], v[22:25]
    s_waitcnt vmcnt(2)
    v_mfma_f32_16x16x16_bf16 v[26:29], v[98:99], v[106:107], v[26:29]
    v_mfma_f32_16x16x16_bf16 v[30:33], v[98:99], v[108:109], v[30:33]
    s_branch K2_S0
K2_L0_1:
    s_cmp_lg_u32 s84, 9
    s_cbranch_scc1 K2_L0_2
    s_waitcnt vmcnt(3)
    v_mfma_f32_16x16x16_bf16 v[34:37], v[98:99], v[102:103], v[34:37]
    v_mfma_f32_16x16x16_bf16 v[38:41], v[98:99], v[104:105], v[38:41]
    s_waitcnt vmcnt(2)
    v_mfma_f32_16x16x16_bf16 v[42:45], v[98:99], v[106:107], v[42:45]
    v_mfma_f32_16x16x16_bf16 v[46:49], v[98:99], v[108:109], v[46:49]
    s_branch K2_S1
K2_L0_2:
    s_cmp_lg_u32 s84, 10
    s_cbranch_scc1 K2_L0_3
    s_waitcnt vmcnt(3)
    v_mfma_f32_16x16x16_bf16 v[50:53], v[98:99], v[102:103], v[50:53]
    v_mfma_f32_16x16x16_bf16 v[54:57], v[98:99], v[104:105], v[54:57]
    s_waitcnt vmcnt(2)
    v_mfma_f32_16x16x16_bf16 v[58:61], v[98:99], v[106:107], v[58:61]
    v_mfma_f32_16x16x16_bf16 v[62:65], v[98:99], v[108:109], v[62:65]
    s_branch K2_S2
K2_L0_3:
    s_cmp_lg_u32 s84, 11
    s_cbranch_scc1 K2_L0_4
    s_waitcnt vmcnt(3)
    v_mfma_f32_16x16x16_bf16 v[66:69], v[98:99], v[102:103], v[66:69]
    v_mfma_f32_16x16x16_bf16 v[70:73], v[98:99], v[104:105], v[70:73]
    s_waitcnt vmcnt(2)
    v_mfma_f32_16x16x16_bf16 v[74:77], v[98:99], v[106:107], v[74:77]
    v_mfma_f32_16x16x16_bf16 v[78:81], v[98:99], v[108:109], v[78:81]
    s_branch K2_S3
K2_L0_4:
    s_waitcnt vmcnt(3)
    v_mfma_f32_16x16x16_bf16 v[82:85], v[98:99], v[102:103], v[82:85]
    v_mfma_f32_16x16x16_bf16 v[86:89], v[98:99], v[104:105], v[86:89]
    s_waitcnt vmcnt(2)
    v_mfma_f32_16x16x16_bf16 v[90:93], v[98:99], v[106:107], v[90:93]
    v_mfma_f32_16x16x16_bf16 v[94:97], v[98:99], v[108:109], v[94:97]
    s_branch K2_S4
K2_nr_1:
    s_lshl_b64 s[46:47], s[44:45], s80
    s_and_b64 s[46:47], s[46:47], s[56:57]
    s_cselect_b32 s55, 0, s48
    s_or_b32 s84, s84, s55
K2_ns_1:
    s_ff1_i32_b64 s58, s[56:57]
    s_cmp_lt_i32 s58, 0
    s_cbranch_scc1 K2_fin_1
    v_readlane_b32 s55, v6, s58
    s_bitset0_b64 s[56:57], s58
    s_and_b32 s80, s58, 7
    s_lshr_b32 s53, s55, 18
    s_and_b32 s55, s55, 0x3ffff
    v_add_u32 v7, s55, v2
    s_cmp_lt_u32 s58, s81
    s_cbranch_scc1 K2_bk_1
    s_setprio 2
    s_mov_b32 s81, 48
    s_cmp_lt_u32 s58, s81
    s_cbranch_scc1 K2_bk_1
    s_setprio 1
    s_mov_b32 s81, 56
    s_cmp_lt_u32 s58, s81
    s_cbranch_scc1 K2_bk_1
    s_setprio 0
    s_mov_b32 s81, 64
    s_branch K2_bk_1
K2_fin_1:
    s_mov_b32 s52, 0
    s_branch K2_D1
K2_C1_01:
    s_cmp_eq_u32 s85, 0
    s_cbranch_scc1 K2_C1_0
    s_waitcnt vmcnt(3)
    v_mfma_f32_16x16x16_bf16 v[34:37], v[100:101], v[110:111], v[34:37]
    v_mfma_f32_16x16x16_bf16 v[38:41], v[100:101], v[112:113], v[38:41]
    s_waitcnt vmcnt(2)
    v_mfma_f32_16x16x16_bf16 v[42:45], v[100:101], v[114:115], v[42:45]
    v_mfma_f32_16x16x16_bf16 v[46:49], v[100:101], v[116:117], v[46:49]
    s_branch K2_M0
K2_C1_0:
    s_waitcnt vmcnt(3)
    v_mfma_f32_16x16x16_bf16 v[18:21], v[100:101], v[110:111], v[18:21]
    v_mfma_f32_16x16x16_bf16 v[22:25], v[100:101], v[112:113], v[22:25]
    s_waitcnt vmcnt(2)
    v_mfma_f32_16x16x16_bf16 v[26:29], v[100:101], v[114:115], v[26:29]
    v_mfma_f32_16x16x16_bf16 v[30:33], v[100:101], v[116:117], v[30:33]
    s_branch K2_M0
K2_C1_2:
    s_cmp_lg_u32 s85, 2
    s_cbranch_scc1 K2_C1_4
    s_waitcnt vmcnt(3)
    v_mfma_f32_16x16x16_bf16 v[50:53], v[100:101], v[110:111], v[50:53]
    v_mfma_f32_16x16x16_bf16 v[54:57], v[100:101], v[112:113], v[54:57]
    s_waitcnt vmcnt(2)
    v_mfma_f32_16x16x16_bf16 v[58:61], v[100:101], v[114:115], v[58:61]
    v_mfma_f32_16x16x16_bf16 v[62:65], v[100:101], v[116:117], v[62:65]
    s_branch K2_M0
K2_C1_4:
    s_cmp_lg_u32 s85, 4
    s_cbranch_scc1 K2_C1_8
    s_waitcnt vmcnt(3)
    v_mfma_f32_16x16x16_bf16 v[82:85], v[100:101], v[110:111], v[82:85]
    v_mfma_f32_16x16x16_bf16 v[86:89], v[100:101], v[112:113], v[86:89]
    s_waitcnt vmcnt(2)
    v_mfma_f32_16x16x16_bf16 v[90:93], v[100:101], v[114:115], v[90:93]
    v_mfma_f32_16x16x16_bf16 v[94:97], v[100:101], v[116:117], v[94:97]
    s_branch K2_M0
K2_T1:
    s_sub_u32 s54, s54, 1
    s_cbranch_scc1 K2_done
    v_perm_b32 v100, v11, v10, v3
    v_perm_b32 v101, v11, v10, v4
    s_waitcnt vmcnt(0)
    s_branch K2_D1
K2_C1_8:
    s_cmp_lt_u32 s85, 8
    s_cbranch_scc1 K2_M0
    s_mov_b32 s86, 0
    s_cmp_lg_u32 s85, 8
    s_cbranch_scc1 K2_L1_1
    s_waitcnt vmcnt(3)
    v_mfma_f32_16x16x16_bf16 v[18:21], v[100:101], v[110:111], v[18:21]
    v_mfma_f32_16x16x16_bf16 v[22:25], v[100:101], v[112:113], v[22:25]
    s_waitcnt vmcnt(2)
    v_mfma_f32_16x16x16_bf16 v[26:29], v[100:101], v[114:115], v[26:29]
    v_mfma_f32_16x16x16_bf16 v[30:33], v[100:101], v[116:117], v[30:33]
    s_branch K2_S0
K2_L1_1:
    s_cmp_lg_u32 s85, 9
    s_cbranch_scc1 K2_L1_2
    s_waitcnt vmcnt(3)
    v_mfma_f32_16x16x16_bf16 v[34:37], v[100:101], v[110:111], v[34:37]
    v_mfma_f32_16x16x16_bf16 v[38:41], v[100:101], v[112:113], v[38:41]
    s_waitcnt vmcnt(2)
    v_mfma_f32_16x16x16_bf16 v[42:45], v[100:101], v[114:115], v[42:45]
    v_mfma_f32_16x16x16_bf16 v[46:49], v[100:101], v[116:117], v[46:49]
    s_branch K2_S1
K2_L1_2:
    s_cmp_lg_u32 s85, 10
    s_cbranch_scc1 K2_L1_3
    s_waitcnt vmcnt(3)
    v_mfma_f32_16x16x16_bf16 v[50:53], v[100:101], v[110:111], v[50:53]
    v_mfma_f32_16x16x16_bf16 v[54:57], v[100:101], v[112:113], v[54:57]
    s_waitcnt vmcnt(2)
    v_mfma_f32_16x16x16_bf16 v[58:61], v[100:101], v[114:115], v[58:61]
    v_mfma_f32_16x16x16_bf16 v[62:65], v[100:101], v[116:117], v[62:65]
    s_branch K2_S2
K2_L1_3:
    s_cmp_lg_u32 s85, 11
    s_cbranch_scc1 K2_L1_4
    s_waitcnt vmcnt(3)
    v_mfma_f32_16x16x16_bf16 v[66:69], v[100:101], v[110:111], v[66:69]
    v_mfma_f32_16x16x16_bf16 v[70:73], v[100:101], v[112:113], v[70:73]
    s_waitcnt vmcnt(2)
    v_mfma_f32_16x16x16_bf16 v[74:77], v[100:101], v[114:115], v[74:77]
    v_mfma_f32_16x16x16_bf16 v[78:81], v[100:101], v[116:117], v[78:81]
    s_branch K2_S3
K2_L1_4:
    s_waitcnt vmcnt(3)
    v_mfma_f32_16x16x16_bf16 v[82:85], v[100:101], v[110:111], v[82:85]
    v_mfma_f32_16x16x16_bf16 v[86:89], v[100:101], v[112:113], v[86:89]
    s_waitcnt vmcnt(2)
    v_mfma_f32_16x16x16_bf16 v[90:93], v[100:101], v[114:115], v[90:93]
    v_mfma_f32_16x16x16_bf16 v[94:97], v[100:101], v[116:117], v[94:97]
    s_branch K2_S4
K2_S0:
    s_bitset0_b32 s87, 0
    s_cmp_lt_u32 s86, 1
    s_nop 4
    v_cvt_pk_bf16_f32 v18, v18, v22
    v_cvt_pk_bf16_f32 v26, v26, v30
    v_add_f32_dpp v19, v29, v19 quad_perm:[0,1,2,3] row_mask:0xf bank_mask:0xc
    v_add_f32_dpp v23, v33, v23 quad_perm:[0,1,2,3] row_mask:0xf bank_mask:0xc
    ds_write2st64_b32 v9, v18, v26 offset0:0 offset1:1
    v_subrev_f32_dpp v21, v27, v21 quad_perm:[0,1,2,3] row_mask:0xf bank_mask:0xc
    v_subrev_f32_dpp v25, v31, v25 quad_perm:[0,1,2,3] row_mask:0xf bank_mask:0xc
    v_sub_f32_dpp v20, v27, v20 row_ror:8 row_mask:0xf bank_mask:0xc
    v_sub_f32_dpp v24, v31, v24 row_ror:8 row_mask:0xf bank_mask:0xc
    v_add_f32_dpp v19, v28, v19 row_ror:8 row_mask:0xf bank_mask:0xc
    v_add_f32_dpp v23, v32, v23 row_ror:8 row_mask:0xf bank_mask:0xc
    v_subrev_f32_dpp v28, v29, v28 row_ror:8 row_mask:0xf bank_mask:0xc
    v_subrev_f32_dpp v32, v33, v32 row_ror:8 row_mask:0xf bank_mask:0xc
    v_cvt_pk_bf16_f32 v21, v21, v25
    v_cvt_pk_bf16_f32 v20, v20, v24
    v_cvt_pk_bf16_f32 v19, v19, v23
    v_cvt_pk_bf16_f32 v28, v28, v32
    ds_write2st64_b32 v9, v20, v21 offset0:3 offset1:4
    ds_write2st64_b32 v9, v19, v28 offset0:2 offset1:5
    s_mov_b64 exec, 1
    ds_add_u32 v1, v14 offset:7184
    s_mov_b64 exec, -1
    s_cbranch_scc1 K2_M0
    s_cmp_eq_u32 s86, 1
    s_cbranch_scc1 K2_M1
    s_branch K2_rest
K2_S1:
    s_bitset0_b32 s87, 1
    s_cmp_lt_u32 s86, 1
    s_nop 4
    v_cvt_pk_bf16_f32 v34, v34, v38
    v_cvt_pk_bf16_f32 v42, v42, v46
    v_add_f32_dpp v35, v45, v35 quad_perm:[0,1,2,3] row_mask:0xf bank_mask:0xc
    v_add_f32_dpp v39, v49, v39 quad_perm:[0,1,2,3] row_mask:0xf bank_mask:0xc
    ds_write2st64_b32 v9, v34, v42 offset0:74 offset1:75
    v_subrev_f32_dpp v37, v43, v37 quad_perm:[0,1,2,3] row_mask:0xf bank_mask:0xc
    v_subrev_f32_dpp v41, v47, v41 quad_perm:[0,1,2,3] row_mask:0xf bank_mask:0xc
    v_sub_f32_dpp v36, v43, v36 row_ror:8 row_mask:0xf bank_mask:0xc
    v_sub_f32_dpp v40, v47, v40 row_ror:8 row_mask:0xf bank_mask:0xc
    v_add_f32_dpp v35, v44, v35 row_ror:8 row_mask:0xf bank_mask:0xc
    v_add_f32_dpp v39, v48, v39 row_ror:8 row_mask:0xf bank_mask:0xc
    v_subrev_f32_dpp v44, v45, v44 row_ror:8 row_mask:0xf bank_mask:0xc
    v_subrev_f32_dpp v48, v49, v48 row_ror:8 row_mask:0xf bank_mask:0xc
    v_cvt_pk_bf16_f32 v37, v37, v41
    v_cvt_pk_bf16_f32 v36, v36, v40
    v_cvt_pk_bf16_f32 v35, v35, v39
    v_cvt_pk_bf16_f32 v44, v44, v48
    ds_write2st64_b32 v9, v36, v37 offset0:77 offset1:78
    ds_write2st64_b32 v9, v35, v44 offset0:76 offset1:79
    s_mov_b64 exec, 1
    ds_add_u32 v1, v14 offset:7188
    s_mov_b64 exec, -1
    s_cbranch_scc1 K2_M0
    s_cmp_eq_u32 s86, 1
    s_cbranch_scc1 K2_M1
    s_branch K2_rest
K2_S2:
    s_bitset0_b32 s87, 2
    s_cmp_lt_u32 s86, 1
    s_nop 4
    v_cvt_pk_bf16_f32 v50, v50, v54
    v_cvt_pk_bf16_f32 v58, v58, v62
    v_add_f32_dpp v51, v61, v51 quad_perm:[0,1,2,3] row_mask:0xf bank_mask:0xc
    v_add_f32_dpp v55, v65, v55 quad_perm:[0,1,2,3] row_mask:0xf bank_mask:0xc
    ds_write2st64_b32 v9, v50, v58 offset0:148 offset1:149
    v_subrev_f32_dpp v53, v59, v53 quad_perm:[0,1,2,3] row_mask:0xf bank_mask:0xc
    v_subrev_f32_dpp v57, v63, v57 quad_perm:[0,1,2,3] row_mask:0xf bank_mask:0xc
    v_sub_f32_dpp v52, v59, v52 row_ror:8 row_mask:0xf bank_mask:0xc
    v_sub_f32_dpp v56, v63, v56 row_ror:8 row_mask:0xf bank_mask:0xc
    v_add_f32_dpp v51, v60, v51 row_ror:8 row_mask:0xf bank_mask:0xc
    v_add_f32_dpp v55, v64, v55 row_ror:8 row_mask:0xf bank_mask:0xc
    v_subrev_f32_dpp v60, v61, v60 row_ror:8 row_mask:0xf bank_mask:0xc
    v_subrev_f32_dpp v64, v65, v64 row_ror:8 row_mask:0xf bank_mask:0xc
    v_cvt_pk_bf16_f32 v53, v53, v57
    v_cvt_pk_bf16_f32 v52, v52, v56
    v_cvt_pk_bf16_f32 v51, v51, v55
    v_cvt_pk_bf16_f32 v60, v60, v64
    ds_write2st64_b32 v9, v52, v53 offset0:151 offset1:152
    ds_write2st64_b32 v9, v51, v60 offset0:150 offset1:153
    s_mov_b64 exec, 1
    ds_add_u32 v1, v14 offset:7192
    s_mov_b64 exec, -1
    s_cbranch_scc1 K2_M0
    s_cmp_eq_u32 s86, 1
    s_cbranch_scc1 K2_M1
    s_branch K2_rest
K2_S3:
    s_bitset0_b32 s87, 3
    s_cmp_lt_u32 s86, 1
    s_nop 4
    v_cvt_pk_bf16_f32 v66, v66, v70
    v_cvt_pk_bf16_f32 v74, v74, v78
    v_add_f32_dpp v67, v77, v67 quad_perm:[0,1,2,3] row_mask:0xf bank_mask:0xc
    v_add_f32_dpp v71, v81, v71 quad_perm:[0,1,2,3] row_mask:0xf bank_mask:0xc
    ds_write2st64_b32 v9, v66, v74 offset0:222 offset1:223
    v_subrev_f32_dpp v69, v75, v69 quad_perm:[0,1,2,3] row_mask:0xf bank_mask:0xc
    v_subrev_f32_dpp v73, v79, v73 quad_perm:[0,1,2,3] row_mask:0xf bank_mask:0xc
    v_sub_f32_dpp v68, v75, v68 row_ror:8 row_mask:0xf bank_mask:0xc
    v_sub_f32_dpp v72, v79, v72 row_ror:8 row_mask:0xf bank_mask:0xc
    v_add_f32_dpp v67, v76, v67 row_ror:8 row_mask:0xf bank_mask:0xc
    v_add_f32_dpp v71, v80, v71 row_ror:8 row_mask:0xf bank_mask:0xc
    v_subrev_f32_dpp v76, v77, v76 row_ror:8 row_mask:0xf bank_mask:0xc
    v_subrev_f32_dpp v80, v81, v80 row_ror:8 row_mask:0xf bank_mask:0xc
    v_cvt_pk_bf16_f32 v69, v69, v73
    v_cvt_pk_bf16_f32 v68, v68, v72
    v_cvt_pk_bf16_f32 v67, v67, v71
    v_cvt_pk_bf16_f32 v76, v76, v80
    ds_write2st64_b32 v9, v68, v69 offset0:225 offset1:226
    ds_write2st64_b32 v9, v67, v76 offset0:224 offset1:227
    s_mov_b64 exec, 1
    ds_add_u32 v1, v14 offset:7196
    s_mov_b64 exec, -1
    s_cbranch_scc1 K2_M0
    s_cmp_eq_u32 s86, 1
    s_cbranch_scc1 K2_M1
    s_branch K2_rest
K2_S4:
    v_add_u32 v15, 1568, v9
    s_bitset0_b32 s87, 4
    s_cmp_lt_u32 s86, 1
    s_nop 4
    v_cvt_pk_bf16_f32 v82, v82, v86
    v_cvt_pk_bf16_f32 v90, v90, v94
    v_add_f32_dpp v83, v93, v83 quad_perm:[0,1,2,3] row_mask:0xf bank_mask:0xc
    v_add_f32_dpp v87, v97, v87 quad_perm:[0,1,2,3] row_mask:0xf bank_mask:0xc
    ds_write2st64_b32 v15, v82, v90 offset0:222 offset1:223
    v_subrev_f32_dpp v85, v91, v85 quad_perm:[0,1,2,3] row_mask:0xf bank_mask:0xc
    v_subrev_f32_dpp v89, v95, v89 quad_perm:[0,1,2,3] row_mask:0xf bank_mask:0xc
    v_sub_f32_dpp v84, v91, v84 row_ror:8 row_mask:0xf bank_mask:0xc
    v_sub_f32_dpp v88, v95, v88 row_ror:8 row_mask:0xf bank_mask:0xc
    v_add_f32_dpp v83, v92, v83 row_ror:8 row_mask:0xf bank_mask:0xc
    v_add_f32_dpp v87, v96, v87 row_ror:8 row_mask:0xf bank_mask:0xc
    v_subrev_f32_dpp v92, v93, v92 row_ror:8 row_mask:0xf bank_mask:0xc
    v_subrev_f32_dpp v96, v97, v96 row_ror:8 row_mask:0xf bank_mask:0xc
    v_cvt_pk_bf16_f32 v85, v85, v89
    v_cvt_pk_bf16_f32 v84, v84, v88
    v_cvt_pk_bf16_f32 v83, v83, v87
    v_cvt_pk_bf16_f32 v92, v92, v96
    ds_write2st64_b32 v15, v84, v85 offset0:225 offset1:226
    ds_write2st64_b32 v15, v83, v92 offset0:224 offset1:227
    s_mov_b64 exec, 1
    ds_add_u32 v1, v14 offset:7196
    s_mov_b64 exec, -1
    s_cbranch_scc1 K2_M0
    s_cmp_eq_u32 s86, 1
    s_cbranch_scc1 K2_M1
K2_rest:
    s_bitcmp1_b32 s87, 0
    s_cbranch_scc1 K2_S0
    s_bitcmp1_b32 s87, 1
    s_cbranch_scc1 K2_S1
    s_bitcmp1_b32 s87, 2
    s_cbranch_scc1 K2_S2
    s_bitcmp1_b32 s87, 3
    s_cbranch_scc1 K2_S3
    s_bitcmp1_b32 s87, 4
    s_cbranch_scc1 K2_S4
    s_waitcnt lgkmcnt(0)
    s_branch K2_exit
K2_done:
    s_cmp_lg_u32 s51, 0
    s_cbranch_scc1 K2_next
    s_mov_b32 s86, 2
    s_branch K2_rest
P_w11:
    v_add_u32 v118, s63, v16
    v_and_b32 v118, 0x7ff, v118
    v_mov_b32 v6, 159232
    ds_write_b64 v6, v[18:19]
K2_w11:
    v_mov_b32 v6, 4
    v_mov_b32 v7, 4
    v_mov_b32 v8, 4
    v_mov_b32 v9, 4
    v_mov_b32 v10, 4
    v_mov_b32 v11, 4
    v_mov_b32 v12, 4
    v_mov_b32 v13, 4
    s_mov_b32 exec_hi, 0xffffff
K2_w11p:
    s_waitcnt lgkmcnt(0)
    ds_read_b64 v[14:15], v1 offset:7168
    ds_read_b128 v[6:9], v118 offset:0
    ds_read_b128 v[10:13], v118 offset:16
    s_waitcnt lgkmcnt(2)
    v_readfirstlane_b32 s55, v15
    s_cmp_lt_u32 s55, 44
    s_cbranch_scc1 K2_w11p
    s_setprio 3
    v_readfirstlane_b32 s51, v14
    s_mov_b32 exec_hi, -1
    s_waitcnt lgkmcnt(1)
    v_add_u32 v7, v7, v6
    v_add_u32 v8, v8, v7
    v_add_u32 v9, v9, v8
    s_waitcnt lgkmcnt(0)
    v_add3_u32 v14, v10, v11, v12
    v_add3_u32 v14, v14, v13, v9
    v_add_u32 v15, 15, v14
    v_and_b32 v15, -16, v15
    v_mov_b32 v17, v15
    v_add_u32 v10, v10, v9
    v_add_u32 v11, v11, v10
    v_add_u32_dpp v17, v17, v17 row_shr:1 row_mask:0xf bank_mask:0xf bound_ctrl:0
    v_add_u32 v12, v12, v11
    v_sub_u32 v98, 87808, v15
    v_add_u32_dpp v17, v17, v17 row_shr:2 row_mask:0xf bank_mask:0xf bound_ctrl:0
    s_nop 1
    v_add_u32_dpp v17, v17, v17 row_shr:4 row_mask:0xf bank_mask:0xf bound_ctrl:0
    s_nop 1
    v_add_u32_dpp v17, v17, v17 row_shr:8 row_mask:0xf bank_mask:0xf bound_ctrl:0
    s_nop 1
    v_add_u32_dpp v17, v17, v17 row_bcast:15 row_mask:0xa bank_mask:0xf
    s_nop 1
    v_add_u32_dpp v17, v17, v17 row_bcast:31 row_mask:0xc bank_mask:0xf
    s_nop 0
    v_readlane_b32 s55, v17, 63
    v_add_u32 v17, v98, v17
    v_add_u32 v13, v17, v12
    v_add_u32 v12, v17, v11
    v_add_u32 v11, v17, v10
    v_add_u32 v10, v17, v9
    s_cmp_gt_u32 s55, 14708
    s_cselect_b32 s55, 18, 16
    ds_write_b128 v118, v[10:13] offset:2064
    v_add_u32 v9, v17, v8
    v_add_u32 v8, v17, v7
    v_add_u32 v7, v17, v6
    v_mov_b32 v6, v17
    v_mov_b32 v98, s55
    ds_write_b128 v118, v[6:9] offset:2048
    s_mov_b64 exec, 1
    ds_or_b32 v2, v98 offset:7168
    s_mov_b64 exec, -1
    s_or_b32 s51, s51, s55
    s_and_b32 s55, s51, 3
    s_cbranch_scc1 K2_bad
    s_cmp_lg_u32 s82, 0
    s_cbranch_scc1 K2_ranked
    s_mov_b32 s82, 1
    v_min_u32 v98, 496, v15
    v_mov_b32 v99, 0
    v_mov_b32 v100, -1
    v_mov_b32 v101, 131071
    v_and_b32 v104, 16, v98
    v_cmp_ne_u32 s[4:5], 0, v104
    v_and_b32 v104, 32, v98
    v_cmp_ne_u32 s[6:7], 0, v104
    v_and_b32 v104, 64, v98
    v_cmp_ne_u32 s[8:9], 0, v104
    v_and_b32 v104, 128, v98
    v_cmp_ne_u32 s[10:11], 0, v104
    v_and_b32 v104, 256, v98
    v_cmp_ne_u32 s[12:13], 0, v104
    s_nop 1
    v_and_b32 v102, s12, v100
    v_and_b32 v103, s13, v101
    v_bcnt_u32_b32 v104, v102, v99
    v_xor_b32 v100, v100, v102
    v_bcnt_u32_b32 v104, v103, v104
    v_xor_b32 v101, v101, v103
    v_cndmask_b32 v100, v100, v102, s[12:13]
    v_cndmask_b32 v99, v104, v99, s[12:13]
    v_cndmask_b32 v101, v101, v103, s[12:13]
    v_and_b32 v102, s10, v100
    v_and_b32 v103, s11, v101
    v_bcnt_u32_b32 v104, v102, v99
    v_xor_b32 v100, v100, v102
    v_bcnt_u32_b32 v104, v103, v104
    v_xor_b32 v101, v101, v103
    v_cndmask_b32 v100, v100, v102, s[10:11]
    v_cndmask_b32 v99, v104, v99, s[10:11]
    v_cndmask_b32 v101, v101, v103, s[10:11]
    v_and_b32 v102, s8, v100
    v_and_b32 v103, s9, v101
    v_bcnt_u32_b32 v104, v102, v99
    v_xor_b32 v100, v100, v102
    v_bcnt_u32_b32 v104, v103, v104
    v_xor_b32 v101, v101, v103
    v_cndmask_b32 v100, v100, v102, s[8:9]
    v_cndmask_b32 v99, v104, v99, s[8:9]
    v_cndmask_b32 v101, v101, v103, s[8:9]
    v_and_b32 v102, s6, v100
    v_and_b32 v103, s7, v101
    v_bcnt_u32_b32 v104, v102, v99
    v_xor_b32 v100, v100, v102
    v_bcnt_u32_b32 v104, v103, v104
    v_xor_b32 v101, v101, v103
    v_cndmask_b32 v100, v100, v102, s[6:7]
    v_cndmask_b32 v99, v104, v99, s[6:7]
    v_cndmask_b32 v101, v101, v103, s[6:7]
    v_and_b32 v102, s4, v100
    v_and_b32 v103, s5, v101
    v_bcnt_u32_b32 v104, v102, v99
    v_xor_b32 v100, v100, v102
    v_bcnt_u32_b32 v104, v103, v104
    v_xor_b32 v101, v101, v103
    v_cndmask_b32 v100, v100, v102, s[4:5]
    v_cndmask_b32 v99, v104, v99, s[4:5]
    v_cndmask_b32 v101, v101, v103, s[4:5]
    v_mbcnt_lo_u32_b32 v99, v100, v99
    v_mbcnt_hi_u32_b32 v99, v101, v99
    v_mul_u32_u24 v104, 47, v99
    v_lshrrev_b32 v104, 9, v104
    v_mul_u32_u24 v102, 11, v104
    v_sub_u32 v102, v99, v102
    v_and_b32 v103, 1, v104
    v_cmp_eq_u32 vcc, 1, v103
    v_sub_u32 v103, 10, v102
    v_cmp_eq_u32 s[4:5], 4, v104
    v_cndmask_b32 v103, v102, v103, vcc
    s_nop 0
    v_cndmask_b32 v104, v104, v102, s[4:5]
    v_cndmask_b32 v103, v103, 11, s[4:5]
    v_lshlrev_b32 v104, 2, v104
    s_mul_i32 s55, s88, 25088
    v_lshl_add_u32 v5, v103, 8, v104
    v_lshl_add_u32 v104, v104, 2, v103
    v_lshl_add_u32 v102, v16, 4, s55
    v_min_u32 v104, 60, v104
    v_add_u32 v5, 4096, v5
    v_lshlrev_b32 v104, 2, v104
    s_mov_b32 exec_hi, 131071
    ds_write_b32 v104, v102 offset:7680
    s_mov_b32 exec_hi, -1
K2_ranked:
    v_mov_b32 v108, 4294908800
    v_add_u32 v109, v17, v15
    v_add_u32 v110, v17, v14
    v_sub_u32 v111, v15, v14
    v_cmp_lt_u32 s[4:5], 0, v111
    v_cmp_lt_u32 s[6:7], 4, v111
    v_cmp_lt_u32 s[8:9], 8, v111
    v_add_u32 v7, 15, v7
    v_add_u32 v8, 15, v8
    v_add_u32 v9, 15, v9
    v_add_u32 v10, 15, v10
    v_add_u32 v11, 15, v11
    v_add_u32 v12, 15, v12
    v_add_u32 v13, 15, v13
    v_and_b32 v7, -16, v7
    v_and_b32 v8, -16, v8
    v_and_b32 v9, -16, v9
    v_and_b32 v10, -16, v10
    v_and_b32 v11, -16, v11
    v_and_b32 v12, -16, v12
    v_and_b32 v13, -16, v13
    s_mov_b64 exec, s[4:5]
    ds_write_b32 v110, v108 offset:0
    s_mov_b64 exec, s[6:7]
    ds_write_b32 v110, v108 offset:4
    s_mov_b64 exec, s[8:9]
    ds_write_b32 v110, v108 offset:8
    s_mov_b32 exec_lo, -1
    s_mov_b32 exec_hi, 131071
    v_sub_u32 v98, v7, v6
    v_sub_u32 v99, v8, v7
    v_sub_u32 v100, v9, v8
    v_sub_u32 v101, v10, v9
    v_sub_u32 v102, v11, v10
    v_sub_u32 v103, v12, v11
    v_sub_u32 v104, v13, v12
    v_sub_u32 v105, v109, v13
    v_cmp_ne_u32 s[4:5], 0, v98
    v_cmp_ne_u32 s[6:7], 0, v99
    v_cmp_ne_u32 s[8:9], 0, v100
    v_cmp_ne_u32 s[10:11], 0, v101
    v_cmp_ne_u32 s[12:13], 0, v102
    v_cmp_ne_u32 s[14:15], 0, v103
    v_cmp_ne_u32 s[16:17], 0, v104
    v_cmp_ne_u32 s[18:19], 0, v105
    v_subrev_u32 v98, 16, v98
    v_subrev_u32 v99, 16, v99
    v_subrev_u32 v100, 16, v100
    v_subrev_u32 v101, 16, v101
    v_subrev_u32 v102, 16, v102
    v_subrev_u32 v103, 16, v103
    v_subrev_u32 v104, 16, v104
    v_subrev_u32 v105, 16, v105
    v_lshl_or_b32 v98, v98, 14, v6
    v_lshl_or_b32 v99, v99, 14, v7
    v_lshl_or_b32 v100, v100, 14, v8
    v_lshl_or_b32 v101, v101, 14, v9
    v_lshl_or_b32 v102, v102, 14, v10
    v_lshl_or_b32 v103, v103, 14, v11
    v_lshl_or_b32 v104, v104, 14, v12
    v_lshl_or_b32 v105, v105, 14, v13
    v_cndmask_b32 v98, 0, v98, s[4:5]
    v_cndmask_b32 v99, 0, v99, s[6:7]
    v_cndmask_b32 v100, 0, v100, s[8:9]
    v_cndmask_b32 v101, 0, v101, s[10:11]
    v_cndmask_b32 v102, 0, v102, s[12:13]
    v_cndmask_b32 v103, 0, v103, s[14:15]
    v_cndmask_b32 v104, 0, v104, s[16:17]
    v_cndmask_b32 v105, 0, v105, s[18:19]
    ds_write2_b32 v5, v98, v99 offset0:0 offset1:8
    ds_write2_b32 v5, v100, v101 offset0:16 offset1:24
    ds_write2_b32 v5, v102, v103 offset0:32 offset1:40
    ds_write2_b32 v5, v104, v105 offset0:48 offset1:56
    s_mov_b64 exec, -1
    v_lshlrev_b32 v7, 2, v0
    s_mul_i32 s55, s3, 1568
    s_add_u32 s55, s55, 7936
    s_mov_b32 s97, 102912
    v_add3_u32 v9, v2, v1, s55
    v_mov_b32 v14, 1
    s_mov_b32 s53, 0
    s_mov_b32 s54, 1
    s_mov_b32 s52, 1
    s_and_b32 s51, s51, 8
    s_cselect_b32 s48, 0, 8
    s_mov_b32 s84, 7
    s_mov_b32 s85, 7
    s_mov_b32 s81, 32
    s_branch K2_join
H_entry:
    s_mov_b32 s93, 21400
    s_mov_b32 s94, -49
    s_mov_b32 s95, 671
    s_mov_b32 s96, 0xffff0000
    s_mov_b32 s63, 256
    v_and_b32 v15, 63, v0
    s_cmp_lg_u32 s3, 12
    s_cbranch_scc1 H_123
    s_setprio 3
    s_mul_i32 s55, s2, 53
    s_add_u32 s55, s55, 786432
    v_add_u32 v9, s55, v15
    v_lshlrev_b32 v10, 1, v9
    v_lshlrev_b32 v9, 2, v9
    v_add_u32 v11, v9, v10
    v_mov_b32 v84, 0
    v_mov_b32 v86, 0
    v_mov_b32 v87, 0
    v_mov_b32 v88, 0
    s_mov_b32 exec_hi, 2097151
    s_waitcnt lgkmcnt(0)
    global_load_dword v122, v13, s[26:27]
    global_load_dword v76, v9, s[12:13]
    global_load_dword v80, v9, s[10:11]
    global_load_short_d16_hi v84, v10, s[8:9]
    global_load_short_d16_hi v86, v11, s[6:7] offset:0
    global_load_short_d16_hi v87, v11, s[6:7] offset:2
    global_load_short_d16_hi v88, v11, s[6:7] offset:4
    s_mov_b32 exec_hi, -1
    s_barrier
    s_mov_b32 s36, s26
    s_mov_b32 s37, s27
    s_mov_b32 s38, 10194944
    s_mov_b32 s39, 0x20000
    s_mul_i32 s97, s2, 12544
    s_add_u32 s97, s97, 561152
    s_add_u32 s55, s97, 12544
    s_mov_b32 s40, s26
    s_mov_b32 s41, s27
    s_mov_b32 s42, s55
    s_mov_b32 s43, 0x20000
    v_mov_b32 v14, 4
    v_lshlrev_b32 v17, 4, v15
    v_add_u32 v8, 50176, v17
    s_mov_b32 exec_hi, 2097151
    s_waitcnt vmcnt(5)
    ds_write_b32 v13, v122 offset:7208
    v_mul_u32_u24 v92, s93, v76
    v_lshrrev_b32 v92, 20, v92
    v_mad_i32_i24 v76, v92, s94, v76
    v_lshlrev_b32 v92, 2, v92
    ds_add_rtn_u32 v96, v92, v14 offset:2048
    s_mov_b32 exec_hi, -1
    s_waitcnt lgkmcnt(0)
    s_barrier
    ds_read_b128 v[112:115], v17 offset:2048
    s_waitcnt vmcnt(0)
    v_readfirstlane_b32 s89, v122
    s_add_u32 s89, s89, 2654435769
    s_waitcnt lgkmcnt(0)
    v_add3_u32 v116, v112, v113, v114
    v_add_u32 v116, v116, v115
    v_mov_b32 v117, v116
    v_mul_u32_u24 v100, s95, v80
    v_lshrrev_b32 v100, 20, v100
    v_add_u32_dpp v117, v117, v117 row_shr:1 row_mask:0xf bank_mask:0xf bound_ctrl:0
    v_lshl_or_b32 v100, v76, 3, v100
    v_lshl_or_b32 v100, v80, 14, v100
    v_add_u32_dpp v117, v117, v117 row_shr:2 row_mask:0xf bank_mask:0xf bound_ctrl:0
    v_lshl_add_u32 v100, v100, 2, s63
    v_mul_f32 v86, v84, v86
    v_add_u32_dpp v117, v117, v117 row_shr:4 row_mask:0xf bank_mask:0xf bound_ctrl:0
    v_mul_f32 v87, v84, v87
    v_mul_f32 v88, v84, v88
    v_add_u32_dpp v117, v117, v117 row_shr:8 row_mask:0xf bank_mask:0xf bound_ctrl:0
    v_cvt_pk_bf16_f32 v104, v84, v86
    v_cvt_pk_bf16_f32 v105, v87, v88
    v_add_u32_dpp v117, v117, v117 row_bcast:15 row_mask:0xa bank_mask:0xf
    s_nop 1
    v_add_u32_dpp v117, v117, v117 row_bcast:31 row_mask:0xc bank_mask:0xf
    v_sub_u32 v118, v117, v116
    v_add_u32 v119, v118, v112
    v_add_u32 v120, v119, v113
    v_add_u32 v121, v120, v114
    ds_write_b128 v17, v[118:121] offset:3072
    s_mov_b32 exec_hi, 2097151
    ds_read_b32 v92, v92 offset:3072
    s_mov_b32 exec_hi, -1
    s_and_b32 s55, s89, 0xff
    v_lshl_or_b32 v68, v112, 6, s55
    v_mov_b32 v69, s89
    v_lshl_or_b32 v70, v113, 6, s55
    v_mov_b32 v71, s89
    v_lshl_or_b32 v72, v114, 6, s55
    v_mov_b32 v73, s89
    v_lshl_or_b32 v74, v115, 6, s55
    v_mov_b32 v75, s89
    v_lshl_or_b32 v68, v118, 18, v68
    v_lshl_or_b32 v70, v119, 18, v70
    v_lshl_or_b32 v72, v120, 18, v72
    v_lshl_or_b32 v74, v121, 18, v74
    s_mov_b32 exec_hi, 2097151
    s_waitcnt lgkmcnt(0)
    v_add_u32 v92, v92, v96
    v_lshlrev_b32 v96, 1, v92
    ds_write_b32 v92, v100 offset:50176
    ds_write_b64 v96, v[104:105] offset:62720
    s_mov_b64 exec, 1
    ds_add_u32 v13, v14 offset:7176
    s_mov_b64 exec, -1
    v_mov_b32 v12, v17
H_wa:
    ds_read_b32 v9, v13 offset:7204
    s_waitcnt lgkmcnt(0)
    v_readfirstlane_b32 s55, v9
    s_cmp_lt_u32 s55, 48
    s_cbranch_scc1 H_wa
    ds_read_b128 v[16:19], v8 offset:0
    ds_read_b128 v[20:23], v8 offset:1024
    ds_read_b128 v[24:27], v8 offset:2048
    ds_read_b128 v[28:31], v8 offset:3072
    ds_read_b128 v[32:35], v8 offset:4096
    ds_read_b128 v[36:39], v8 offset:5120
    ds_read_b128 v[40:43], v8 offset:6144
    ds_read_b128 v[44:47], v8 offset:7168
    ds_read_b128 v[48:51], v8 offset:8192
    ds_read_b128 v[52:55], v8 offset:9216
    ds_read_b128 v[56:59], v8 offset:10240
    ds_read_b128 v[60:63], v8 offset:11264
    ds_read_b128 v[64:67], v8 offset:12288
    s_waitcnt lgkmcnt(12)
    buffer_store_dwordx4 v[16:19], v12, s[40:43], s97 offen offset:0 sc1
    s_waitcnt lgkmcnt(11)
    buffer_store_dwordx4 v[20:23], v12, s[40:43], s97 offen offset:1024 sc1
    s_waitcnt lgkmcnt(10)
    buffer_store_dwordx4 v[24:27], v12, s[40:43], s97 offen offset:2048 sc1
    s_waitcnt lgkmcnt(9)
    buffer_store_dwordx4 v[28:31], v12, s[40:43], s97 offen offset:3072 sc1
    s_add_u32 s97, s97, 4096
    s_waitcnt lgkmcnt(8)
    buffer_store_dwordx4 v[32:35], v12, s[40:43], s97 offen offset:0 sc1
    s_waitcnt lgkmcnt(7)
    buffer_store_dwordx4 v[36:39], v12, s[40:43], s97 offen offset:1024 sc1
    s_waitcnt lgkmcnt(6)
    buffer_store_dwordx4 v[40:43], v12, s[40:43], s97 offen offset:2048 sc1
    s_waitcnt lgkmcnt(5)
    buffer_store_dwordx4 v[44:47], v12, s[40:43], s97 offen offset:3072 sc1
    s_add_u32 s97, s97, 4096
    s_waitcnt lgkmcnt(4)
    buffer_store_dwordx4 v[48:51], v12, s[40:43], s97 offen offset:0 sc1
    s_waitcnt lgkmcnt(3)
    buffer_store_dwordx4 v[52:55], v12, s[40:43], s97 offen offset:1024 sc1
    s_waitcnt lgkmcnt(2)
    buffer_store_dwordx4 v[56:59], v12, s[40:43], s97 offen offset:2048 sc1
    s_waitcnt lgkmcnt(1)
    buffer_store_dwordx4 v[60:63], v12, s[40:43], s97 offen offset:3072 sc1
    s_add_u32 s97, s97, 4096
    s_waitcnt lgkmcnt(0)
    buffer_store_dwordx4 v[64:67], v12, s[40:43], s97 offen offset:0 sc1
    s_lshl_b32 s58, s2, 11
    s_add_u32 s58, s58, 4096
    s_waitcnt vmcnt(0)
    buffer_store_dwordx4 v[68:71], v12, s[36:39], s58 offen sc1
    buffer_store_dwordx4 v[72:75], v12, s[36:39], s58 offen offset:1024 sc1
    s_mov_b64 exec, 1
    ds_add_u32 v13, v14 offset:7220
    s_mov_b64 exec, -1
    s_waitcnt vmcnt(0)
    s_mov_b64 exec, 1
    ds_add_u32 v13, v14 offset:7212
    s_mov_b64 exec, -1
    s_branch H_set
H_123:
    s_sub_u32 s55, s3, 13
    s_mul_i32 s55, s55, 3
    s_add_u32 s58, s55, 4
    s_cmp_eq_u32 s3, 15
    s_cselect_b32 s55, 0, s55
    s_cselect_b32 s58, 0, s58
    s_lshl_b32 s55, s55, 12
    v_lshrrev_b32 v9, 4, v15
    v_bfe_u32 v10, v15, 3, 1
    v_lshl_add_u32 v9, v9, 2, v10
    v_and_b32 v10, 7, v15
    v_lshl_add_u32 v10, v10, 4, s55
    v_lshl_add_u32 v10, v9, 8, v10
    s_lshl_b32 s55, s58, 6
    v_lshl_add_u32 v11, v9, 2, s55
    s_cmp_eq_u32 s3, 15
    s_waitcnt lgkmcnt(0)
    s_cselect_b64 s[62:63], s[16:17], s[18:19]
    s_barrier
    s_mov_b32 s36, s26
    s_mov_b32 s37, s27
    s_mov_b32 s38, 10194944
    s_mov_b32 s39, 0x20000
    s_mul_i32 s97, s2, 25088
    s_add_u32 s97, s97, 3772416
    s_add_u32 s55, s97, 25088
    s_mov_b32 s40, s26
    s_mov_b32 s41, s27
    s_mov_b32 s42, s55
    s_mov_b32 s43, 0x20000
    s_sub_u32 s55, s3, 13
    s_mul_i32 s55, s55, 13312
    s_add_u32 s97, s97, s55
    s_add_u32 s55, s55, 62720
    v_lshlrev_b32 v12, 4, v15
    v_add_u32 v8, s55, v12
    v_and_b32 v6, 1, v15
    v_lshlrev_b32 v6, 7, v6
    v_and_b32 v9, 48, v15
    v_lshl_add_u32 v6, v9, 4, v6
    v_and_b32 v9, 6, v15
    v_mul_u32_u24 v9, 528, v9
    v_add_u32 v6, v6, v9
    v_and_b32 v9, 8, v15
    s_mul_i32 s55, s58, 4224
    s_add_u32 s55, s55, 7936
    v_add3_u32 v6, v6, v9, s55
    s_barrier
    ds_read_b32 v122, v13 offset:7208
    global_load_dwordx4 v[68:71], v10, s[62:63] offset:0
    global_load_dwordx4 v[72:75], v10, s[62:63] offset:512
    global_load_dwordx4 v[76:79], v10, s[62:63] offset:128
    global_load_dwordx4 v[80:83], v10, s[62:63] offset:640
    global_load_dword v84, v11, s[14:15] offset:0
    global_load_dword v85, v11, s[14:15] offset:8
    v_add_u32 v10, 0x1000, v10
    global_load_dwordx4 v[86:89], v10, s[62:63] offset:0
    global_load_dwordx4 v[90:93], v10, s[62:63] offset:512
    global_load_dwordx4 v[94:97], v10, s[62:63] offset:128
    global_load_dwordx4 v[98:101], v10, s[62:63] offset:640
    global_load_dword v102, v11, s[14:15] offset:64
    global_load_dword v103, v11, s[14:15] offset:72
    v_add_u32 v10, 0x1000, v10
    global_load_dwordx4 v[104:107], v10, s[62:63] offset:0
    global_load_dwordx4 v[108:111], v10, s[62:63] offset:512
    global_load_dwordx4 v[112:115], v10, s[62:63] offset:128
    global_load_dwordx4 v[116:119], v10, s[62:63] offset:640
    global_load_dword v120, v11, s[14:15] offset:128
    global_load_dword v121, v11, s[14:15] offset:136
    v_add_u32 v10, 0x1000, v10
    s_cmp_lg_u32 s3, 15
    s_cbranch_scc1 H_w3
    global_load_dwordx4 v[40:43], v10, s[62:63] offset:0
    global_load_dwordx4 v[44:47], v10, s[62:63] offset:512
    global_load_dwordx4 v[48:51], v10, s[62:63] offset:128
    global_load_dwordx4 v[52:55], v10, s[62:63] offset:640
    global_load_dword v56, v11, s[14:15] offset:192
    global_load_dword v57, v11, s[14:15] offset:200
H_w3:
    s_cmp_eq_u32 s3, 15
    s_cbranch_scc1 H_f3
H_wb:
    ds_read_b32 v9, v13 offset:7176
    s_waitcnt lgkmcnt(0)
    v_readfirstlane_b32 s55, v9
    s_cmp_lt_u32 s55, 52
    s_cbranch_scc1 H_wb
    s_setprio 3
    ds_read_b128 v[16:19], v8 offset:0
    ds_read_b128 v[20:23], v8 offset:1024
    ds_read_b128 v[24:27], v8 offset:2048
    ds_read_b128 v[28:31], v8 offset:3072
    ds_read_b128 v[32:35], v8 offset:4096
    ds_read_b128 v[36:39], v8 offset:5120
    ds_read_b128 v[40:43], v8 offset:6144
    ds_read_b128 v[44:47], v8 offset:7168
    ds_read_b128 v[48:51], v8 offset:8192
    ds_read_b128 v[52:55], v8 offset:9216
    ds_read_b128 v[56:59], v8 offset:10240
    ds_read_b128 v[60:63], v8 offset:11264
    ds_read_b128 v[64:67], v8 offset:12288
H_wq:
    ds_read_b32 v9, v13 offset:7220
    s_waitcnt lgkmcnt(0)
    v_readfirstlane_b32 s55, v9
    s_cmp_lt_u32 s55, 1
    s_cbranch_scc1 H_wq
    buffer_store_dwordx4 v[16:19], v12, s[40:43], s97 offen offset:0 sc1
    buffer_store_dwordx4 v[20:23], v12, s[40:43], s97 offen offset:1024 sc1
    buffer_store_dwordx4 v[24:27], v12, s[40:43], s97 offen offset:2048 sc1
    buffer_store_dwordx4 v[28:31], v12, s[40:43], s97 offen offset:3072 sc1
    s_add_u32 s97, s97, 4096
    buffer_store_dwordx4 v[32:35], v12, s[40:43], s97 offen offset:0 sc1
    buffer_store_dwordx4 v[36:39], v12, s[40:43], s97 offen offset:1024 sc1
    buffer_store_dwordx4 v[40:43], v12, s[40:43], s97 offen offset:2048 sc1
    buffer_store_dwordx4 v[44:47], v12, s[40:43], s97 offen offset:3072 sc1
    s_add_u32 s97, s97, 4096
    buffer_store_dwordx4 v[48:51], v12, s[40:43], s97 offen offset:0 sc1
    buffer_store_dwordx4 v[52:55], v12, s[40:43], s97 offen offset:1024 sc1
    buffer_store_dwordx4 v[56:59], v12, s[40:43], s97 offen offset:2048 sc1
    buffer_store_dwordx4 v[60:63], v12, s[40:43], s97 offen offset:3072 sc1
    s_add_u32 s97, s97, 4096
    buffer_store_dwordx4 v[64:67], v12, s[40:43], s97 offen offset:0 sc1
    s_setprio 0
    s_waitcnt vmcnt(13)
    s_branch H_fold
H_f3:
    s_waitcnt vmcnt(0) lgkmcnt(0)
H_fold:
    v_readfirstlane_b32 s89, v122
    s_add_u32 s89, s89, 2654435769
    v_and_b32 v16, 0xffff, v84
    v_lshlrev_b32 v17, 16, v84
    v_and_b32 v18, 0xffff, v85
    v_lshlrev_b32 v19, 16, v85
    v_lshrrev_b32 v20, 16, v84
    v_and_b32 v21, s96, v84
    v_lshrrev_b32 v22, 16, v85
    v_and_b32 v23, s96, v85
    v_dot2_f32_bf16 v24, v68, v16, 0
    v_dot2_f32_bf16 v25, v72, v18, 0
    v_dot2_f32_bf16 v26, v76, v20, 0
    v_dot2_f32_bf16 v27, v80, v22, 0
    v_dot2_f32_bf16 v28, v68, v17, 0
    v_dot2_f32_bf16 v29, v72, v19, 0
    v_dot2_f32_bf16 v30, v76, v21, 0
    v_dot2_f32_bf16 v31, v80, v23, 0
    v_cvt_pk_bf16_f32 v32, v24, v25
    v_cvt_pk_bf16_f32 v33, v26, v27
    s_nop 0
    v_cvt_pk_bf16_f32 v34, v28, v29
    v_cvt_pk_bf16_f32 v35, v30, v31
    ds_write2_b64 v6, v[32:33], v[34:35] offset0:0 offset1:2
    v_dot2_f32_bf16 v24, v69, v16, 0
    v_dot2_f32_bf16 v25, v73, v18, 0
    v_dot2_f32_bf16 v26, v77, v20, 0
    v_dot2_f32_bf16 v27, v81, v22, 0
    v_dot2_f32_bf16 v28, v69, v17, 0
    v_dot2_f32_bf16 v29, v73, v19, 0
    v_dot2_f32_bf16 v30, v77, v21, 0
    v_dot2_f32_bf16 v31, v81, v23, 0
    v_cvt_pk_bf16_f32 v36, v24, v25
    v_cvt_pk_bf16_f32 v37, v26, v27
    s_nop 0
    v_cvt_pk_bf16_f32 v38, v28, v29
    v_cvt_pk_bf16_f32 v39, v30, v31
    ds_write2_b64 v6, v[36:37], v[38:39] offset0:4 offset1:6
    v_dot2_f32_bf16 v24, v70, v16, 0
    v_dot2_f32_bf16 v25, v74, v18, 0
    v_dot2_f32_bf16 v26, v78, v20, 0
    v_dot2_f32_bf16 v27, v82, v22, 0
    v_dot2_f32_bf16 v28, v70, v17, 0
    v_dot2_f32_bf16 v29, v74, v19, 0
    v_dot2_f32_bf16 v30, v78, v21, 0
    v_dot2_f32_bf16 v31, v82, v23, 0
    v_cvt_pk_bf16_f32 v32, v24, v25
    v_cvt_pk_bf16_f32 v33, v26, v27
    s_nop 0
    v_cvt_pk_bf16_f32 v34, v28, v29
    v_cvt_pk_bf16_f32 v35, v30, v31
    ds_write2_b64 v6, v[32:33], v[34:35] offset0:8 offset1:10
    v_dot2_f32_bf16 v24, v71, v16, 0
    v_dot2_f32_bf16 v25, v75, v18, 0
    v_dot2_f32_bf16 v26, v79, v20, 0
    v_dot2_f32_bf16 v27, v83, v22, 0
    v_dot2_f32_bf16 v28, v71, v17, 0
    v_dot2_f32_bf16 v29, v75, v19, 0
    v_dot2_f32_bf16 v30, v79, v21, 0
    v_dot2_f32_bf16 v31, v83, v23, 0
    v_cvt_pk_bf16_f32 v36, v24, v25
    v_cvt_pk_bf16_f32 v37, v26, v27
    s_nop 0
    v_cvt_pk_bf16_f32 v38, v28, v29
    v_cvt_pk_bf16_f32 v39, v30, v31
    ds_write2_b64 v6, v[36:37], v[38:39] offset0:12 offset1:14
    v_add_u32 v6, 4224, v6
    v_and_b32 v16, 0xffff, v102
    v_lshlrev_b32 v17, 16, v102
    v_and_b32 v18, 0xffff, v103
    v_lshlrev_b32 v19, 16, v103
    v_lshrrev_b32 v20, 16, v102
    v_and_b32 v21, s96, v102
    v_lshrrev_b32 v22, 16, v103
    v_and_b32 v23, s96, v103
    v_dot2_f32_bf16 v24, v86, v16, 0
    v_dot2_f32_bf16 v25, v90, v18, 0
    v_dot2_f32_bf16 v26, v94, v20, 0
    v_dot2_f32_bf16 v27, v98, v22, 0
    v_dot2_f32_bf16 v28, v86, v17, 0
    v_dot2_f32_bf16 v29, v90, v19, 0
    v_dot2_f32_bf16 v30, v94, v21, 0
    v_dot2_f32_bf16 v31, v98, v23, 0
    v_cvt_pk_bf16_f32 v32, v24, v25
    v_cvt_pk_bf16_f32 v33, v26, v27
    s_nop 0
    v_cvt_pk_bf16_f32 v34, v28, v29
    v_cvt_pk_bf16_f32 v35, v30, v31
    ds_write2_b64 v6, v[32:33], v[34:35] offset0:0 offset1:2
    v_dot2_f32_bf16 v24, v87, v16, 0
    v_dot2_f32_bf16 v25, v91, v18, 0
    v_dot2_f32_bf16 v26, v95, v20, 0
    v_dot2_f32_bf16 v27, v99, v22, 0
    v_dot2_f32_bf16 v28, v87, v17, 0
    v_dot2_f32_bf16 v29, v91, v19, 0
    v_dot2_f32_bf16 v30, v95, v21, 0
    v_dot2_f32_bf16 v31, v99, v23, 0
    v_cvt_pk_bf16_f32 v36, v24, v25
    v_cvt_pk_bf16_f32 v37, v26, v27
    s_nop 0
    v_cvt_pk_bf16_f32 v38, v28, v29
    v_cvt_pk_bf16_f32 v39, v30, v31
    ds_write2_b64 v6, v[36:37], v[38:39] offset0:4 offset1:6
    v_dot2_f32_bf16 v24, v88, v16, 0
    v_dot2_f32_bf16 v25, v92, v18, 0
    v_dot2_f32_bf16 v26, v96, v20, 0
    v_dot2_f32_bf16 v27, v100, v22, 0
    v_dot2_f32_bf16 v28, v88, v17, 0
    v_dot2_f32_bf16 v29, v92, v19, 0
    v_dot2_f32_bf16 v30, v96, v21, 0
    v_dot2_f32_bf16 v31, v100, v23, 0
    v_cvt_pk_bf16_f32 v32, v24, v25
    v_cvt_pk_bf16_f32 v33, v26, v27
    s_nop 0
    v_cvt_pk_bf16_f32 v34, v28, v29
    v_cvt_pk_bf16_f32 v35, v30, v31
    ds_write2_b64 v6, v[32:33], v[34:35] offset0:8 offset1:10
    v_dot2_f32_bf16 v24, v89, v16, 0
    v_dot2_f32_bf16 v25, v93, v18, 0
    v_dot2_f32_bf16 v26, v97, v20, 0
    v_dot2_f32_bf16 v27, v101, v22, 0
    v_dot2_f32_bf16 v28, v89, v17, 0
    v_dot2_f32_bf16 v29, v93, v19, 0
    v_dot2_f32_bf16 v30, v97, v21, 0
    v_dot2_f32_bf16 v31, v101, v23, 0
    v_cvt_pk_bf16_f32 v36, v24, v25
    v_cvt_pk_bf16_f32 v37, v26, v27
    s_nop 0
    v_cvt_pk_bf16_f32 v38, v28, v29
    v_cvt_pk_bf16_f32 v39, v30, v31
    ds_write2_b64 v6, v[36:37], v[38:39] offset0:12 offset1:14
    v_add_u32 v6, 4224, v6
    v_and_b32 v16, 0xffff, v120
    v_lshlrev_b32 v17, 16, v120
    v_and_b32 v18, 0xffff, v121
    v_lshlrev_b32 v19, 16, v121
    v_lshrrev_b32 v20, 16, v120
    v_and_b32 v21, s96, v120
    v_lshrrev_b32 v22, 16, v121
    v_and_b32 v23, s96, v121
    v_dot2_f32_bf16 v24, v104, v16, 0
    v_dot2_f32_bf16 v25, v108, v18, 0
    v_dot2_f32_bf16 v26, v112, v20, 0
    v_dot2_f32_bf16 v27, v116, v22, 0
    v_dot2_f32_bf16 v28, v104, v17, 0
    v_dot2_f32_bf16 v29, v108, v19, 0
    v_dot2_f32_bf16 v30, v112, v21, 0
    v_dot2_f32_bf16 v31, v116, v23, 0
    v_cvt_pk_bf16_f32 v32, v24, v25
    v_cvt_pk_bf16_f32 v33, v26, v27
    s_nop 0
    v_cvt_pk_bf16_f32 v34, v28, v29
    v_cvt_pk_bf16_f32 v35, v30, v31
    ds_write2_b64 v6, v[32:33], v[34:35] offset0:0 offset1:2
    v_dot2_f32_bf16 v24, v105, v16, 0
    v_dot2_f32_bf16 v25, v109, v18, 0
    v_dot2_f32_bf16 v26, v113, v20, 0
    v_dot2_f32_bf16 v27, v117, v22, 0
    v_dot2_f32_bf16 v28, v105, v17, 0
    v_dot2_f32_bf16 v29, v109, v19, 0
    v_dot2_f32_bf16 v30, v113, v21, 0
    v_dot2_f32_bf16 v31, v117, v23, 0
    v_cvt_pk_bf16_f32 v36, v24, v25
    v_cvt_pk_bf16_f32 v37, v26, v27
    s_nop 0
    v_cvt_pk_bf16_f32 v38, v28, v29
    v_cvt_pk_bf16_f32 v39, v30, v31
    ds_write2_b64 v6, v[36:37], v[38:39] offset0:4 offset1:6
    v_dot2_f32_bf16 v24, v106, v16, 0
    v_dot2_f32_bf16 v25, v110, v18, 0
    v_dot2_f32_bf16 v26, v114, v20, 0
    v_dot2_f32_bf16 v27, v118, v22, 0
    v_dot2_f32_bf16 v28, v106, v17, 0
    v_dot2_f32_bf16 v29, v110, v19, 0
    v_dot2_f32_bf16 v30, v114, v21, 0
    v_dot2_f32_bf16 v31, v118, v23, 0
    v_cvt_pk_bf16_f32 v32, v24, v25
    v_cvt_pk_bf16_f32 v33, v26, v27
    s_nop 0
    v_cvt_pk_bf16_f32 v34, v28, v29
    v_cvt_pk_bf16_f32 v35, v30, v31
    ds_write2_b64 v6, v[32:33], v[34:35] offset0:8 offset1:10
    v_dot2_f32_bf16 v24, v107, v16, 0
    v_dot2_f32_bf16 v25, v111, v18, 0
    v_dot2_f32_bf16 v26, v115, v20, 0
    v_dot2_f32_bf16 v27, v119, v22, 0
    v_dot2_f32_bf16 v28, v107, v17, 0
    v_dot2_f32_bf16 v29, v111, v19, 0
    v_dot2_f32_bf16 v30, v115, v21, 0
    v_dot2_f32_bf16 v31, v119, v23, 0
    v_cvt_pk_bf16_f32 v36, v24, v25
    v_cvt_pk_bf16_f32 v37, v26, v27
    s_nop 0
    v_cvt_pk_bf16_f32 v38, v28, v29
    v_cvt_pk_bf16_f32 v39, v30, v31
    ds_write2_b64 v6, v[36:37], v[38:39] offset0:12 offset1:14
    v_add_u32 v6, 4224, v6
    s_cmp_lg_u32 s3, 15
    s_cbranch_scc1 H_pub
    v_and_b32 v16, 0xffff, v56
    v_lshlrev_b32 v17, 16, v56
    v_and_b32 v18, 0xffff, v57
    v_lshlrev_b32 v19, 16, v57
    v_lshrrev_b32 v20, 16, v56
    v_and_b32 v21, s96, v56
    v_lshrrev_b32 v22, 16, v57
    v_and_b32 v23, s96, v57
    v_dot2_f32_bf16 v24, v40, v16, 0
    v_dot2_f32_bf16 v25, v44, v18, 0
    v_dot2_f32_bf16 v26, v48, v20, 0
    v_dot2_f32_bf16 v27, v52, v22, 0
    v_dot2_f32_bf16 v28, v40, v17, 0
    v_dot2_f32_bf16 v29, v44, v19, 0
    v_dot2_f32_bf16 v30, v48, v21, 0
    v_dot2_f32_bf16 v31, v52, v23, 0
    v_cvt_pk_bf16_f32 v32, v24, v25
    v_cvt_pk_bf16_f32 v33, v26, v27
    s_nop 0
    v_cvt_pk_bf16_f32 v34, v28, v29
    v_cvt_pk_bf16_f32 v35, v30, v31
    ds_write2_b64 v6, v[32:33], v[34:35] offset0:0 offset1:2
    v_dot2_f32_bf16 v24, v41, v16, 0
    v_dot2_f32_bf16 v25, v45, v18, 0
    v_dot2_f32_bf16 v26, v49, v20, 0
    v_dot2_f32_bf16 v27, v53, v22, 0
    v_dot2_f32_bf16 v28, v41, v17, 0
    v_dot2_f32_bf16 v29, v45, v19, 0
    v_dot2_f32_bf16 v30, v49, v21, 0
    v_dot2_f32_bf16 v31, v53, v23, 0
    v_cvt_pk_bf16_f32 v36, v24, v25
    v_cvt_pk_bf16_f32 v37, v26, v27
    s_nop 0
    v_cvt_pk_bf16_f32 v38, v28, v29
    v_cvt_pk_bf16_f32 v39, v30, v31
    ds_write2_b64 v6, v[36:37], v[38:39] offset0:4 offset1:6
    v_dot2_f32_bf16 v24, v42, v16, 0
    v_dot2_f32_bf16 v25, v46, v18, 0
    v_dot2_f32_bf16 v26, v50, v20, 0
    v_dot2_f32_bf16 v27, v54, v22, 0
    v_dot2_f32_bf16 v28, v42, v17, 0
    v_dot2_f32_bf16 v29, v46, v19, 0
    v_dot2_f32_bf16 v30, v50, v21, 0
    v_dot2_f32_bf16 v31, v54, v23, 0
    v_cvt_pk_bf16_f32 v32, v24, v25
    v_cvt_pk_bf16_f32 v33, v26, v27
    s_nop 0
    v_cvt_pk_bf16_f32 v34, v28, v29
    v_cvt_pk_bf16_f32 v35, v30, v31
    ds_write2_b64 v6, v[32:33], v[34:35] offset0:8 offset1:10
    v_dot2_f32_bf16 v24, v43, v16, 0
    v_dot2_f32_bf16 v25, v47, v18, 0
    v_dot2_f32_bf16 v26, v51, v20, 0
    v_dot2_f32_bf16 v27, v55, v22, 0
    v_dot2_f32_bf16 v28, v43, v17, 0
    v_dot2_f32_bf16 v29, v47, v19, 0
    v_dot2_f32_bf16 v30, v51, v21, 0
    v_dot2_f32_bf16 v31, v55, v23, 0
    v_cvt_pk_bf16_f32 v36, v24, v25
    v_cvt_pk_bf16_f32 v37, v26, v27
    s_nop 0
    v_cvt_pk_bf16_f32 v38, v28, v29
    v_cvt_pk_bf16_f32 v39, v30, v31
    ds_write2_b64 v6, v[36:37], v[38:39] offset0:12 offset1:14
    v_mov_b32 v9, 1
    s_mov_b64 exec, 1
    ds_add_u32 v13, v9 offset:7216
    s_mov_b64 exec, -1
    s_branch H_set
H_pub:
    s_setprio 3
    v_mov_b32 v9, 1
    s_mov_b64 exec, 1
    ds_add_u32 v13, v9 offset:7216
    s_mov_b64 exec, -1
    v_lshlrev_b32 v12, 11, v15
    v_mov_b32 v10, s89
    v_mov_b32 v11, s89
    s_lshl_b32 s58, s2, 3
    s_add_u32 s58, s58, 528384
    s_mov_b64 exec, 1
    s_waitcnt vmcnt(0)
    ds_add_rtn_u32 v9, v13, v9 offset:7180
    s_waitcnt lgkmcnt(0)
    v_readfirstlane_b32 s55, v9
    s_mov_b64 exec, 65535
    s_cmp_eq_u32 s55, 0
    s_cbranch_scc1 H_np
    buffer_store_dwordx2 v[10:11], v12, s[36:39], s58 offen sc1
H_np:
    s_mov_b64 exec, -1
H_set:
    s_setprio 0
    s_mov_b32 s28, s4
    s_mov_b32 s29, s5
    s_mov_b32 s30, 6400000
    s_mov_b32 s31, 0x20000
    s_mov_b32 s32, s22
    s_mov_b32 s33, s23
    s_mov_b32 s34, 6400000
    s_mov_b32 s35, 0x20000
    s_and_b32 s88, s2, 7
    s_lshl_b32 s88, s88, 5
    s_lshr_b32 s55, s2, 3
    s_add_u32 s88, s88, s55
    s_mov_b32 s49, 0
    s_mov_b32 s50, 32
    s_mov_b32 s90, 0
    v_mov_b32 v7, 0
    v_lshlrev_b32 v16, 5, v15
    v_mov_b32 v124, 0
    s_mov_b32 m0, 7424
H_wf:
    ds_read_b32 v9, v7 offset:7216
    s_waitcnt lgkmcnt(0)
    v_readfirstlane_b32 s55, v9
    s_cmp_lt_u32 s55, 3
    s_cbranch_scc1 H_wf
    s_and_b32 s58, s3, 3
    s_mul_i32 s55, s58, 1056
    v_lshrrev_b32 v7, 1, v16
    v_add_u32 v9, s55, v7
    ds_read_b128 v[84:87], v9 offset:7936
    ds_read_b128 v[88:91], v9 offset:12160
    ds_read_b128 v[92:95], v9 offset:16384
    ds_read_b128 v[96:99], v9 offset:20608
    ds_read_b128 v[100:103], v9 offset:24832
    ds_read_b128 v[104:107], v9 offset:29056
    ds_read_b128 v[108:111], v9 offset:33280
    ds_read_b128 v[112:115], v9 offset:37504
    ds_read_b128 v[116:119], v9 offset:41728
    ds_read_b128 v[120:123], v9 offset:45952
    v_and_b32 v10, 15, v0
    v_and_b32 v11, 48, v0
    v_mul_u32_u24 v1, 1568, v10
    v_mul_u32_u24 v2, 528, v10
    v_add_u32 v1, v1, v11
    v_add_u32 v1, 7936, v1
    v_lshrrev_b32 v11, 1, v11
    s_lshl_b32 s55, s58, 5
    v_add3_u32 v2, v2, v11, s55
    v_and_b32 v5, 0x1f0, v7
    v_bfe_u32 v10, v0, 5, 3
    v_mul_u32_u24 v3, 528, v10
    v_add_u32 v3, v3, v5
    v_lshlrev_b32 v4, 2, v10
    v_add_u32 v4, 7680, v4
    v_mov_b32 v7, 0
    s_cmp_lg_u32 s3, 15
    s_cbranch_scc1 H_rnd
H_wp:
    s_sleep 1
    ds_read_b32 v9, v7 offset:7168
    s_waitcnt lgkmcnt(0)
    v_readfirstlane_b32 s55, v9
    s_cmp_lt_u32 s55, 16
    s_cbranch_scc1 H_wp
    s_mul_i32 s58, s2, 6272
    v_and_b32 v14, 63, v0
    v_lshlrev_b32 v14, 7, v14
    s_mov_b32 exec_hi, 0x1ffff
    buffer_load_dword v14, s[28:31], s58 offen  lds
    s_add_u32 s58, s58, 1605632
    buffer_load_dword v14, s[28:31], s58 offen  lds
    s_mov_b32 exec_hi, -1
H_rnd:
    s_waitcnt lgkmcnt(0)
    s_barrier
    ds_read_b32 v11, v7 offset:7168
    v_mov_b32 v6, 0
    s_mov_b32 s53, 0
    s_lshl4_add_u32 s55, s90, s3
    s_cmp_eq_u32 s55, 15
    s_cselect_b32 s52, 0, 9
    v_mov_b32 v14, 1
    s_waitcnt lgkmcnt(0)
    v_readfirstlane_b32 s51, v11
    s_and_b32 s55, s51, 11
    s_cbranch_scc1 K2_disp
    s_and_b32 s55, s3, 3
    s_mul_i32 s55, s55, 1664
    s_mul_i32 s58, s2, 6272
    s_add_u32 s58, s58, s55
    s_add_u32 s58, s58, 3211264
    s_buffer_load_dword s54, s[28:31], s58 offset:0
    s_buffer_load_dword s54, s[28:31], s58 offset:64
    s_buffer_load_dword s54, s[28:31], s58 offset:128
    s_buffer_load_dword s54, s[28:31], s58 offset:192
    s_waitcnt lgkmcnt(0)
    s_buffer_load_dword s54, s[28:31], s58 offset:256
    s_buffer_load_dword s54, s[28:31], s58 offset:320
    s_buffer_load_dword s54, s[28:31], s58 offset:384
    s_buffer_load_dword s54, s[28:31], s58 offset:448
    s_waitcnt lgkmcnt(0)
    s_buffer_load_dword s54, s[28:31], s58 offset:512
    s_buffer_load_dword s54, s[28:31], s58 offset:576
    s_buffer_load_dword s54, s[28:31], s58 offset:640
    s_buffer_load_dword s54, s[28:31], s58 offset:704
    s_waitcnt lgkmcnt(0)
    s_buffer_load_dword s54, s[28:31], s58 offset:768
    s_buffer_load_dword s54, s[28:31], s58 offset:832
    s_buffer_load_dword s54, s[28:31], s58 offset:896
    s_buffer_load_dword s54, s[28:31], s58 offset:960
    s_waitcnt lgkmcnt(0)
    s_buffer_load_dword s54, s[28:31], s58 offset:1024
    s_buffer_load_dword s54, s[28:31], s58 offset:1088
    s_buffer_load_dword s54, s[28:31], s58 offset:1152
    s_buffer_load_dword s54, s[28:31], s58 offset:1216
    s_waitcnt lgkmcnt(0)
    s_buffer_load_dword s54, s[28:31], s58 offset:1280
    s_buffer_load_dword s54, s[28:31], s58 offset:1344
    s_buffer_load_dword s54, s[28:31], s58 offset:1408
    s_buffer_load_dword s54, s[28:31], s58 offset:1472
    s_waitcnt lgkmcnt(0)
    s_buffer_load_dword s54, s[28:31], s58 offset:1536
    s_buffer_load_dword s54, s[28:31], s58 offset:1600
    s_add_u32 s58, s58, 1605632
    s_waitcnt lgkmcnt(0)
    s_buffer_load_dword s54, s[28:31], s58 offset:0
    s_buffer_load_dword s54, s[28:31], s58 offset:64
    s_buffer_load_dword s54, s[28:31], s58 offset:128
    s_buffer_load_dword s54, s[28:31], s58 offset:192
    s_waitcnt lgkmcnt(0)
    s_buffer_load_dword s54, s[28:31], s58 offset:256
    s_buffer_load_dword s54, s[28:31], s58 offset:320
    s_buffer_load_dword s54, s[28:31], s58 offset:384
    s_buffer_load_dword s54, s[28:31], s58 offset:448
    s_waitcnt lgkmcnt(0)
    s_buffer_load_dword s54, s[28:31], s58 offset:512
    s_buffer_load_dword s54, s[28:31], s58 offset:576
    s_buffer_load_dword s54, s[28:31], s58 offset:640
    s_buffer_load_dword s54, s[28:31], s58 offset:704
    s_waitcnt lgkmcnt(0)
    s_buffer_load_dword s54, s[28:31], s58 offset:768
    s_buffer_load_dword s54, s[28:31], s58 offset:832
    s_buffer_load_dword s54, s[28:31], s58 offset:896
    s_buffer_load_dword s54, s[28:31], s58 offset:960
    s_waitcnt lgkmcnt(0)
    s_buffer_load_dword s54, s[28:31], s58 offset:1024
    s_buffer_load_dword s54, s[28:31], s58 offset:1088
    s_buffer_load_dword s54, s[28:31], s58 offset:1152
    s_buffer_load_dword s54, s[28:31], s58 offset:1216
    s_waitcnt lgkmcnt(0)
    s_buffer_load_dword s54, s[28:31], s58 offset:1280
    s_buffer_load_dword s54, s[28:31], s58 offset:1344
    s_buffer_load_dword s54, s[28:31], s58 offset:1408
    s_buffer_load_dword s54, s[28:31], s58 offset:1472
    s_waitcnt lgkmcnt(0)
    s_buffer_load_dword s54, s[28:31], s58 offset:1536
    s_buffer_load_dword s54, s[28:31], s58 offset:1600
    s_waitcnt lgkmcnt(0)
H_loop:
    s_setprio 0
    ds_read2_b32 v[8:9], v4 offset0:0 offset1:8
    s_cmp_eq_u32 s53, 3
    s_cselect_b32 s54, 13, 12
H_wg:
    s_sleep 2
    ds_read_b32 v11, v6 offset:7184
    s_waitcnt lgkmcnt(0)
    v_readfirstlane_b32 s55, v11
    s_cmp_lt_u32 s55, s54
    s_cbranch_scc1 H_wg
    s_setprio 3
    s_mov_b32 exec_lo, 0x1fff1fff
    s_mov_b32 exec_hi, 0x1fff1fff
    ds_read_b128 v[16:19], v1 offset:0
    ds_read_b128 v[20:23], v1 offset:64
    ds_read_b128 v[24:27], v1 offset:640
    ds_read_b128 v[28:31], v1 offset:704
    ds_read_b128 v[32:35], v1 offset:128
    ds_read_b128 v[36:39], v1 offset:192
    ds_read_b128 v[40:43], v1 offset:512
    ds_read_b128 v[44:47], v1 offset:576
    ds_read_b128 v[48:51], v1 offset:1408
    ds_read_b128 v[52:55], v1 offset:1472
    ds_read_b128 v[56:59], v1 offset:256
    ds_read_b128 v[60:63], v1 offset:320
    s_cmp_lg_u32 s53, s52
    s_cbranch_scc1 H_ne1
    buffer_load_dword v10, off, s[36:39], 0 sc1
H_ne1:
    s_waitcnt lgkmcnt(11)
    v_mfma_f32_16x16x32_bf16 v[64:67], v[84:87], v[16:19], 0
    s_waitcnt lgkmcnt(10)
    v_mfma_f32_16x16x32_bf16 v[64:67], v[88:91], v[20:23], v[64:67]
    ds_read_b128 v[16:19], v1 offset:768
    s_waitcnt lgkmcnt(10)
    v_mfma_f32_16x16x32_bf16 v[64:67], v[92:95], v[24:27], v[64:67]
    ds_read_b128 v[20:23], v1 offset:832
    s_waitcnt lgkmcnt(10)
    v_mfma_f32_16x16x32_bf16 v[64:67], v[96:99], v[28:31], v[64:67]
    ds_read_b128 v[24:27], v1 offset:1152
    s_waitcnt lgkmcnt(10)
    v_mfma_f32_16x16x32_bf16 v[68:71], v[108:111], v[32:35], 0
    ds_read_b128 v[28:31], v1 offset:1216
    s_waitcnt lgkmcnt(10)
    v_mfma_f32_16x16x32_bf16 v[68:71], v[112:115], v[36:39], v[68:71]
    ds_read_b128 v[32:35], v1 offset:384
    s_waitcnt lgkmcnt(10)
    v_mfma_f32_16x16x32_bf16 v[68:71], v[100:103], v[40:43], v[68:71]
    ds_read_b128 v[36:39], v1 offset:448
    v_mul_f32 v80, 0xbfb8aa3b, v64
    v_mul_f32 v81, 0xbfb8aa3b, v65
    s_waitcnt lgkmcnt(10)
    v_mfma_f32_16x16x32_bf16 v[68:71], v[104:107], v[44:47], v[68:71]
    ds_read_b128 v[40:43], v1 offset:1024
    v_mul_f32 v82, 0xbfb8aa3b, v66
    v_mul_f32 v83, 0xbfb8aa3b, v67
    s_waitcnt lgkmcnt(10)
    v_mfma_f32_16x16x32_bf16 v[68:71], v[116:119], v[48:51], v[68:71]
    ds_read_b128 v[44:47], v1 offset:1088
    v_exp_f32 v80, v80
    v_exp_f32 v81, v81
    s_waitcnt lgkmcnt(10)
    v_mfma_f32_16x16x32_bf16 v[68:71], v[120:123], v[52:55], v[68:71]
    ds_read_b128 v[48:51], v1 offset:896
    v_exp_f32 v82, v82
    v_exp_f32 v83, v83
    s_waitcnt lgkmcnt(10)
    v_mfma_f32_16x16x32_bf16 v[72:75], v[108:111], v[56:59], 0
    ds_read_b128 v[52:55], v1 offset:960
    v_add_f32 v80, 1.0, v80
    v_add_f32 v81, 1.0, v81
    s_waitcnt lgkmcnt(10)
    v_mfma_f32_16x16x32_bf16 v[72:75], v[112:115], v[60:63], v[72:75]
    v_add_f32 v82, 1.0, v82
    v_add_f32 v83, 1.0, v83
    v_rcp_f32 v80, v80
    s_waitcnt lgkmcnt(9)
    v_mfma_f32_16x16x32_bf16 v[72:75], v[100:103], v[16:19], v[72:75]
    v_rcp_f32 v81, v81
    v_rcp_f32 v82, v82
    v_rcp_f32 v83, v83
    s_waitcnt lgkmcnt(8)
    v_mfma_f32_16x16x32_bf16 v[72:75], v[104:107], v[20:23], v[72:75]
    v_cvt_pk_bf16_f32 v64, v64, v65
    v_cvt_pk_bf16_f32 v65, v66, v67
    ds_write_b64 v2, v[64:65] offset:0
    s_waitcnt lgkmcnt(8)
    v_mfma_f32_16x16x32_bf16 v[72:75], v[116:119], v[24:27], v[72:75]
    v_mul_f32 v68, v68, v80
    v_mul_f32 v69, v69, v81
    v_mul_f32 v70, v70, v82
    s_waitcnt lgkmcnt(7)
    v_mfma_f32_16x16x32_bf16 v[72:75], v[120:123], v[28:31], v[72:75]
    v_mul_f32 v71, v71, v83
    v_cvt_pk_bf16_f32 v68, v68, v69
    v_cvt_pk_bf16_f32 v69, v70, v71
    s_waitcnt lgkmcnt(6)
    v_mfma_f32_16x16x32_bf16 v[76:79], v[108:111], v[32:35], 0
    ds_write_b64 v2, v[68:69] offset:128
    s_waitcnt lgkmcnt(6)
    v_mfma_f32_16x16x32_bf16 v[76:79], v[112:115], v[36:39], v[76:79]
    s_waitcnt lgkmcnt(5)
    v_mfma_f32_16x16x32_bf16 v[76:79], v[100:103], v[40:43], v[76:79]
    s_waitcnt lgkmcnt(4)
    v_mfma_f32_16x16x32_bf16 v[76:79], v[104:107], v[44:47], v[76:79]
    v_mul_f32 v72, v72, v80
    v_mul_f32 v73, v73, v81
    v_mul_f32 v74, v74, v82
    s_waitcnt lgkmcnt(3)
    v_mfma_f32_16x16x32_bf16 v[76:79], v[116:119], v[48:51], v[76:79]
    v_mul_f32 v75, v75, v83
    v_cvt_pk_bf16_f32 v72, v72, v73
    v_cvt_pk_bf16_f32 v73, v74, v75
    s_waitcnt lgkmcnt(2)
    v_mfma_f32_16x16x32_bf16 v[76:79], v[120:123], v[52:55], v[76:79]
    ds_write_b64 v2, v[72:73] offset:256
    v_add_u32 v1, 18944, v1
    s_add_u32 s53, s53, 1
    s_lshl_b32 s54, s53, 2
    s_cmp_eq_u32 s53, 1
    s_mov_b32 s58, 18944
    s_cselect_b32 s58, 7936, s58
    s_nop 1
    v_mul_f32 v76, v76, v80
    v_mul_f32 v77, v77, v81
    v_mul_f32 v78, v78, v82
    v_mul_f32 v79, v79, v83
    v_cvt_pk_bf16_f32 v76, v76, v77
    v_cvt_pk_bf16_f32 v77, v78, v79
    ds_write_b64 v2, v[76:77] offset:384
    v_add_u32 v2, s58, v2
    s_mov_b64 exec, 1
    ds_add_u32 v7, v14 offset:7200
    s_mov_b64 exec, -1
    v_add_u32 v8, v8, v5
    v_add_u32 v9, v9, v5
H_w2:
    ds_read_b32 v11, v7 offset:7200
    s_waitcnt lgkmcnt(0)
    v_readfirstlane_b32 s55, v11
    s_cmp_lt_u32 s55, s54
    s_cbranch_scc1 H_w2
    ds_read_b128 v[16:19], v3
    ds_read_b128 v[20:23], v3 offset:4224
    v_add_u32 v3, s58, v3
    v_add_u32 v4, 64, v4
    v_add_u32 v6, 4, v6
    s_cmp_lt_u32 s53, 4
    s_waitcnt lgkmcnt(1)
    buffer_store_dwordx4 v[16:19], v8, s[32:35], 0 offen nt
    s_waitcnt lgkmcnt(0)
    buffer_store_dwordx4 v[20:23], v9, s[32:35], 0 offen nt
    s_cbranch_scc1 H_loop
    s_cmp_lg_u32 s52, 0
    s_cbranch_scc1 K2_exit
    s_mov_b64 exec, 1
    s_waitcnt vmcnt(8)
    v_cmp_ne_u32 vcc, s89, v10
    v_mov_b32 v10, s89
    s_and_b64 exec, exec, vcc
    s_cbranch_execz K2_exit
    buffer_store_dword v10, off, s[36:39], 0 sc1
K2_exit:
K2_end:
    s_endpgm
K2_cold:
P_tmo:
    s_waitcnt vmcnt(0)
    v_mov_b32 v11, 1
    ds_or_b32 v7, v11 offset:7168
    s_mov_b64 s[60:61], 0
    s_branch P_go
K2_ep:
    s_mov_b64 exec, 1
    v_mov_b32 v6, s89
    buffer_store_dword v6, off, s[36:39], 0 sc1
    s_mov_b64 exec, -1
    s_branch K2_join
K2_idle:
    s_waitcnt lgkmcnt(0)
    s_barrier
    s_cmp_eq_u32 s3, 11
    s_cbranch_scc1 K2_w11
    s_branch H_rnd
K2_bad:
    s_barrier
K2_disp:
    s_bitcmp1_b32 s51, 0
    s_cbranch_scc1 K2_slow0
    s_bitcmp1_b32 s51, 1
    s_cbranch_scc1 K2_overflow
K2_next:
    s_add_u32 s49, s49, s50
    s_cmp_lg_u32 s90, 0
    s_cbranch_scc1 K2_slow
K2_overflow:
    s_mov_b32 s50, 13
    s_waitcnt vmcnt(0) lgkmcnt(0)
    s_barrier
    v_lshlrev_b32 v6, 2, v0
    v_mov_b32 v7, 0
    ds_write_b32 v6, v7 offset:0
    ds_write_b32 v7, v7 offset:7168
    ds_write_b32 v7, v7 offset:7172
    s_cmp_ge_u32 s3, 11
    s_cbranch_scc1 K2_idle
    v_mov_b32 v13, 4
    v_and_b32 v14, 0xfc, v6
    v_and_b32 v11, 15, v0
    v_add_u32 v8, s49, v11
    v_lshlrev_b32 v10, 2, v8
    v_add_u32 v8, 1, v8
    v_mov_b32 v9, 0xffff
    v_cmp_gt_u32 vcc, s50, v11
    s_add_u32 s55, s49, s50
    s_mov_b32 s5, 0xffff
    v_cndmask_b32 v8, v9, v8, vcc
    s_waitcnt lgkmcnt(0)
    s_barrier
    s_branch K2_ld
K2_slow0:
    s_mov_b32 s90, 1
    s_mov_b32 s49, 0
    s_mov_b32 s50, 704
K2_slow:
    s_load_dwordx16 s[4:19], s[0:1], 0
    s_waitcnt vmcnt(0) lgkmcnt(0)
    s_barrier
    v_lshlrev_b32 v6, 2, v0
    v_mov_b32 v7, 0
    ds_write_b32 v6, v7 offset:0
    ds_write_b32 v7, v7 offset:7168
    ds_write_b32 v7, v7 offset:7172
    s_cmp_ge_u32 s3, 11
    s_cbranch_scc1 K2_idle
    v_mov_b32 v13, 4
    v_and_b32 v14, 0xfc, v6
    v_add_u32 v6, s49, v0
    v_cmp_gt_u32 vcc, 200000, v6
    s_mov_b64 s[56:57], vcc
    v_min_u32 v6, 199999, v6
    v_lshlrev_b32 v7, 3, v6
    v_lshlrev_b32 v6, 4, v6
    v_add_u32 v8, v6, v7
    global_load_dwordx4 v[82:85], v6, s[12:13]
    global_load_dwordx4 v[86:89], v6, s[10:11]
    global_load_dwordx2 v[90:91], v7, s[8:9]
    global_load_dwordx4 v[92:95], v8, s[6:7]
    global_load_dwordx2 v[96:97], v8, s[6:7] offset:16
    s_waitcnt vmcnt(0)
    v_mov_b32 v7, 0
    v_mul_u32_u24 v116, s93, v82
    v_mul_u32_u24 v117, s93, v83
    v_mul_u32_u24 v118, s93, v84
    v_mul_u32_u24 v119, s93, v85
    v_lshrrev_b32 v116, 20, v116
    v_lshrrev_b32 v117, 20, v117
    v_lshrrev_b32 v118, 20, v118
    v_lshrrev_b32 v119, 20, v119
    v_mad_i32_i24 v82, v116, s94, v82
    v_mad_i32_i24 v83, v117, s94, v83
    v_mad_i32_i24 v84, v118, s94, v84
    v_mad_i32_i24 v85, v119, s94, v85
    v_mul_u32_u24 v110, s95, v86
    v_mul_u32_u24 v111, s95, v87
    v_mul_u32_u24 v112, s95, v88
    v_mul_u32_u24 v113, s95, v89
    v_lshrrev_b32 v110, 20, v110
    v_lshrrev_b32 v111, 20, v111
    v_lshrrev_b32 v112, 20, v112
    v_lshrrev_b32 v113, 20, v113
    v_lshl_or_b32 v110, v82, 3, v110
    v_lshl_or_b32 v111, v83, 3, v111
    v_lshl_or_b32 v112, v84, 3, v112
    v_lshl_or_b32 v113, v85, 3, v113
    v_lshl_or_b32 v110, v86, 14, v110
    v_lshl_or_b32 v111, v87, 14, v111
    v_lshl_or_b32 v112, v88, 14, v112
    v_lshl_or_b32 v113, v89, 14, v113
    v_lshl_add_u32 v110, v110, 2, s63
    v_lshl_add_u32 v111, v111, 2, s63
    v_lshl_add_u32 v112, v112, 2, s63
    v_lshl_add_u32 v113, v113, 2, s63
    v_lshlrev_b32 v9, 16, v90
    v_lshlrev_b32 v10, 16, v92
    v_and_b32 v11, s96, v92
    v_lshlrev_b32 v12, 16, v93
    v_mul_f32 v10, v9, v10
    v_mul_f32 v11, v9, v11
    v_mul_f32 v12, v9, v12
    v_cvt_pk_bf16_f32 v98, v9, v10
    v_cvt_pk_bf16_f32 v99, v11, v12
    v_and_b32 v9, s96, v90
    v_and_b32 v10, s96, v93
    v_lshlrev_b32 v11, 16, v94
    v_and_b32 v12, s96, v94
    v_mul_f32 v10, v9, v10
    v_mul_f32 v11, v9, v11
    v_mul_f32 v12, v9, v12
    v_cvt_pk_bf16_f32 v100, v9, v10
    v_cvt_pk_bf16_f32 v101, v11, v12
    v_lshlrev_b32 v9, 16, v91
    v_lshlrev_b32 v10, 16, v95
    v_and_b32 v11, s96, v95
    v_lshlrev_b32 v12, 16, v96
    v_mul_f32 v10, v9, v10
    v_mul_f32 v11, v9, v11
    v_mul_f32 v12, v9, v12
    v_cvt_pk_bf16_f32 v102, v9, v10
    v_cvt_pk_bf16_f32 v103, v11, v12
    v_and_b32 v9, s96, v91
    v_and_b32 v10, s96, v96
    v_lshlrev_b32 v11, 16, v97
    v_and_b32 v12, s96, v97
    v_mul_f32 v10, v9, v10
    v_mul_f32 v11, v9, v11
    v_mul_f32 v12, v9, v12
    v_cvt_pk_bf16_f32 v104, v9, v10
    v_cvt_pk_bf16_f32 v105, v11, v12
    v_cmp_eq_u32 s[8:9], s88, v116
    v_cmp_eq_u32 s[10:11], s88, v117
    v_cmp_eq_u32 s[12:13], s88, v118
    v_cmp_eq_u32 s[14:15], s88, v119
    s_and_b64 s[8:9], s[8:9], s[56:57]
    s_and_b64 s[10:11], s[10:11], s[56:57]
    s_and_b64 s[12:13], s[12:13], s[56:57]
    s_and_b64 s[14:15], s[14:15], s[56:57]
    v_cndmask_b32 v110, 0, v110, s[8:9]
    v_cndmask_b32 v111, 0, v111, s[10:11]
    v_cndmask_b32 v112, 0, v112, s[12:13]
    v_cndmask_b32 v113, 0, v113, s[14:15]
    v_mov_b32 v114, 0
    v_mov_b32 v115, 0
    v_mov_b32 v88, 0
    s_mov_b32 s4, 0
    s_add_u32 s55, s49, 704
    s_cmp_lt_u32 s55, 200000
    s_cselect_b32 s55, 8, 0
    s_waitcnt lgkmcnt(0)
    s_barrier
    s_branch K2_flag
.section .rodata,"a"
.p2align 6
.amdhsa_kernel gather_scatter__tensor_product_equiv_equiformer__graph_kernel
  .amdhsa_next_free_vgpr 128
  .amdhsa_next_free_sgpr 102
  .amdhsa_accum_offset 128
  .amdhsa_group_segment_fixed_size 0
  .amdhsa_kernarg_size 96
  .amdhsa_user_sgpr_count 2
  .amdhsa_user_sgpr_kernarg_segment_ptr 1
  .amdhsa_system_sgpr_workgroup_id_x 1
.end_amdhsa_kernel
```
